```python
import torch

def _softmax(x, axis=-1):
    return torch.softmax(x, dim=axis)
def _gelu(x):
    return torch.nn.functional.gelu(x, approximate="tanh")
def _silu(x):
    return torch.nn.functional.silu(x)
def _sigmoid(x):
    return torch.sigmoid(x)
def _layernorm(x, axis=-1, eps=1e-5):
    m = x.mean(dim=axis, keepdim=True)
    v = x.var(dim=axis, keepdim=True, unbiased=False)
    return (x - m) / torch.sqrt(v + eps)
def _scatter_add(tgt, idx, src, axis=0):
    return tgt.clone().index_add_(axis, idx, src)
def _segment_sum(src, seg, n):
    out = torch.zeros((n,) + src.shape[1:], dtype=src.dtype)
    return out.index_add_(0, seg, src)
def _pad(x, pw):
    flat = tuple(v for pair in reversed(pw) for v in pair)
    return torch.nn.functional.pad(x, flat)

kernel_name = 'sequential_preLN__gqa_block_cached__geglu_ffn__decode'

def setup_inputs():

    _w = (lambda a: (lambda t: t.to(torch.bfloat16) if t.is_floating_point() else t)(torch.as_tensor(a)))
    def _A_setup():
        B, Sq, D = 1, 1, 448
        Hq, Hkv, Sk, Dh = 16, 8, 8192, 256
        assert Hq % Hkv == 0, (Hq, Hkv)
        return {
            "x": _w((lambda *s: torch.randn(*s, dtype=torch.bfloat16) * 0.05)(B, Sq, D)),
            "k_cache": _w((lambda *s: torch.randn(*s, dtype=torch.bfloat16) * 3.2)(B, Hkv, Sk, Dh)),
            "v_cache": _w((lambda *s: torch.randn(*s, dtype=torch.bfloat16) * 0.4)(B, Hkv, Sk, Dh)),
            "wq": _w((lambda *s: torch.randn(*s, dtype=torch.bfloat16) * 3.2)(D, Hq * Dh) * (D ** -0.5)),
            "wo": _w((lambda *s: torch.randn(*s, dtype=torch.bfloat16) * 0.4)(Hq * Dh, D) * ((Hq * Dh) ** -0.5)),
        }
    _A_in = _A_setup()

    def _B_setup():
        B, S, D, F = 1, 1, 448, 1792
        return {
            "x": _w((lambda *s: torch.randn(*s, dtype=torch.bfloat16) * 0.05)(B, S, D)),
            "w_gate": _w((lambda *s: torch.randn(*s, dtype=torch.bfloat16) * 0.05)(D, F)),
            "w_up": _w((lambda *s: torch.randn(*s, dtype=torch.bfloat16) * 0.05)(D, F)),
            "w_down": _w((lambda *s: torch.randn(*s, dtype=torch.bfloat16) * 0.05)(F, D)),
        }
    _B_in = _B_setup()

    return {
        "A_x": _A_in["x"],
        "A_k_cache": _A_in["k_cache"],
        "A_v_cache": _A_in["v_cache"],
        "A_wq": _A_in["wq"],
        "A_wo": _A_in["wo"],
        "B_x": _B_in["x"],
        "B_w_gate": _B_in["w_gate"],
        "B_w_up": _B_in["w_up"],
        "B_w_down": _B_in["w_down"],
    }

def reference(A_x, A_k_cache, A_v_cache, A_wq, A_wo, B_x, B_w_gate, B_w_up, B_w_down):
    def _A_ref(x, k_cache, v_cache, wq, wo):
        B, Sq, D = x.shape
        Hq, Dh = 16, 256
        Hkv = k_cache.shape[1]
        rep = Hq // Hkv
        q = (lambda x, *d: x.permute(*d))((x @ wq).reshape(B, Sq, Hq, Dh), 0, 2, 1, 3)
        k = (lambda x, n, axis: torch.repeat_interleave(x, n, dim=axis))(k_cache, rep, axis=1)
        v = (lambda x, n, axis: torch.repeat_interleave(x, n, dim=axis))(v_cache, rep, axis=1)
        scores = torch.einsum("bhqd,bhkd->bhqk", q, k) * (Dh ** -0.5)
        p = _softmax(scores, axis=-1)
        o = torch.einsum("bhqk,bhkd->bhqd", p, v)
        return (lambda x, *d: x.permute(*d))(o, 0, 2, 1, 3).reshape(B, Sq, Hq * Dh) @ wo

    def _B_ref(x, w_gate, w_up, w_down):
        return (_gelu(x @ w_gate) * (x @ w_up)) @ w_down

    x = A_x
    h = x + _A_ref(_layernorm(x, axis=-1), A_k_cache, A_v_cache, A_wq, A_wo)
    h2 = h + _B_ref(_layernorm(h, axis=-1), B_w_gate, B_w_up, B_w_down)
    return h2
```

```asm
; @launch grid=(256,1,1) block=(320,1,1) lds=163840
.amdgcn_target "amdgcn-amd-amdhsa--gfx950"
.text
.globl sequential_preLN__gqa_block_cached__geglu_ffn__decode_kernel
.p2align 8
.type sequential_preLN__gqa_block_cached__geglu_ffn__decode_kernel,@function
sequential_preLN__gqa_block_cached__geglu_ffn__decode_kernel:
    s_cmp_ge_u32 s2, 256
    s_cbranch_scc1 L_end
    s_load_dwordx16 s[48:63], s[0:1], 0
    s_load_dwordx8 s[64:71], s[0:1], 64
    v_and_b32 v1, 63, v0
    v_lshrrev_b32 v6, 6, v0
    s_nop 0
    v_readfirstlane_b32 s74, v6
    s_and_b32 s72, s2, 7
    s_lshr_b32 s73, s2, 3
    s_mov_b32 s84, 0x80000000
    s_mov_b32 s89, 0
    v_and_b32 v6, 15, v1
    v_lshrrev_b32 v7, 4, v1
    v_lshlrev_b32 v2, 9, v6
    v_lshl_add_u32 v2, v7, 4, v2
    v_lshlrev_b32 v3, 4, v1
    v_mov_b32 v8, s84
    s_waitcnt lgkmcnt(0)
    s_mov_b32 s4, s50
    s_and_b32 s5, s51, 0xffff
    s_mov_b32 s6, 33554432
    s_mov_b32 s7, 0x00020000
    s_mov_b32 s8, s52
    s_and_b32 s9, s53, 0xffff
    s_mov_b32 s10, 33554432
    s_mov_b32 s11, 0x00020000
    s_mov_b32 s12, s70
    s_and_b32 s13, s71, 0xffff
    s_mov_b32 s14, 774144
    s_mov_b32 s15, 0x00020000
    s_mov_b32 s16, s68
    s_and_b32 s17, s69, 0xffff
    s_mov_b32 s18, 256
    s_mov_b32 s19, 0x00020000
    s_mov_b32 s20, s48
    s_and_b32 s21, s49, 0xffff
    s_mov_b32 s22, 896
    s_mov_b32 s23, 0x00020000
    s_mov_b32 s24, s54
    s_and_b32 s25, s55, 0xffff
    s_mov_b32 s26, 3670016
    s_mov_b32 s27, 0x00020000
    s_mov_b32 s28, s56
    s_and_b32 s29, s57, 0xffff
    s_mov_b32 s30, 3670016
    s_mov_b32 s31, 0x00020000
    s_mov_b32 s32, s60
    s_and_b32 s33, s61, 0xffff
    s_mov_b32 s34, 1605632
    s_mov_b32 s35, 0x00020000
    s_mov_b32 s36, s62
    s_and_b32 s37, s63, 0xffff
    s_mov_b32 s38, 1605632
    s_mov_b32 s39, 0x00020000
    s_mov_b32 s40, s64
    s_and_b32 s41, s65, 0xffff
    s_mov_b32 s42, 1605632
    s_mov_b32 s43, 0x00020000
    s_mov_b32 s44, s66
    s_and_b32 s45, s67, 0xffff
    s_mov_b32 s46, 896
    s_mov_b32 s47, 0x00020000
    s_mov_b32 s87, 0
    s_cmp_lt_u32 s73, 14
    s_cselect_b32 s87, 1, s87
    s_sub_u32 s75, s73, 16
    s_cmp_lt_u32 s75, 14
    s_cselect_b32 s87, 2, s87
    s_sub_u32 s75, s73, 14
    s_cmp_lt_u32 s75, 2
    s_cselect_b32 s76, 1, 0
    s_cmp_lt_u32 s72, 7
    s_cselect_b32 s76, s76, 0
    s_cmp_eq_u32 s76, 1
    s_cselect_b32 s87, 3, s87
    s_cmp_ge_u32 s73, 7
    s_cselect_b32 s75, 1, 0
    s_lshl_b32 s81, s72, 1
    s_add_u32 s81, s81, s75
    s_mul_i32 s75, s75, 7
    s_sub_u32 s82, s73, s75
    s_mul_i32 s83, s72, 14
    s_add_u32 s83, s83, s73
    s_sub_u32 s83, s83, 16
    s_cmp_eq_u32 s74, 4
    s_cbranch_scc1 L_helper
    s_lshl_b32 s79, s72, 22
    s_lshl_b32 s75, s73, 17
    s_add_u32 s79, s79, s75
    s_lshl_b32 s75, s74, 15
    s_add_u32 s79, s79, s75
    s_mov_b32 s80, s79
    s_mov_b32 s88, 32
    s_cmp_eq_u32 s73, 1
    s_cselect_b32 s88, 38, s88
    s_cmp_eq_u32 s73, 2
    s_cselect_b32 s88, 44, s88
    s_cmp_eq_u32 s73, 3
    s_cselect_b32 s88, 50, s88
    s_cmp_eq_u32 s73, 5
    s_cselect_b32 s88, 38, s88
    s_cmp_eq_u32 s73, 6
    s_cselect_b32 s88, 44, s88
    s_cmp_eq_u32 s73, 7
    s_cselect_b32 s88, 50, s88
    s_cmp_eq_u32 s73, 9
    s_cselect_b32 s88, 38, s88
    s_cmp_eq_u32 s73, 10
    s_cselect_b32 s88, 44, s88
    s_cmp_eq_u32 s73, 11
    s_cselect_b32 s88, 50, s88
    s_cmp_eq_u32 s73, 13
    s_cselect_b32 s88, 38, s88
    s_cmp_eq_u32 s73, 14
    s_cselect_b32 s88, 44, s88
    s_cmp_eq_u32 s73, 15
    s_cselect_b32 s88, 50, s88
    s_cmp_eq_u32 s73, 17
    s_cselect_b32 s88, 38, s88
    s_cmp_eq_u32 s73, 18
    s_cselect_b32 s88, 44, s88
    s_cmp_eq_u32 s73, 19
    s_cselect_b32 s88, 50, s88
    s_cmp_eq_u32 s73, 21
    s_cselect_b32 s88, 38, s88
    s_cmp_eq_u32 s73, 22
    s_cselect_b32 s88, 44, s88
    s_cmp_eq_u32 s73, 23
    s_cselect_b32 s88, 50, s88
    s_cmp_eq_u32 s73, 25
    s_cselect_b32 s88, 38, s88
    s_cmp_eq_u32 s73, 26
    s_cselect_b32 s88, 44, s88
    s_cmp_eq_u32 s73, 27
    s_cselect_b32 s88, 50, s88
    s_cmp_eq_u32 s73, 29
    s_cselect_b32 s88, 38, s88
    s_cmp_eq_u32 s73, 30
    s_cselect_b32 s88, 44, s88
    s_cmp_eq_u32 s73, 31
    s_cselect_b32 s88, 50, s88
    s_mov_b32 s3, 0
    s_cmp_eq_u32 s73, 1
    s_cselect_b32 s3, 6, s3
    s_cmp_eq_u32 s73, 2
    s_cselect_b32 s3, 12, s3
    s_cmp_eq_u32 s73, 3
    s_cselect_b32 s3, 18, s3
    s_cmp_eq_u32 s73, 5
    s_cselect_b32 s3, 6, s3
    s_cmp_eq_u32 s73, 6
    s_cselect_b32 s3, 12, s3
    s_cmp_eq_u32 s73, 7
    s_cselect_b32 s3, 18, s3
    s_cmp_eq_u32 s73, 9
    s_cselect_b32 s3, 6, s3
    s_cmp_eq_u32 s73, 10
    s_cselect_b32 s3, 12, s3
    s_cmp_eq_u32 s73, 11
    s_cselect_b32 s3, 18, s3
    s_cmp_eq_u32 s73, 13
    s_cselect_b32 s3, 6, s3
    s_cmp_eq_u32 s73, 14
    s_cselect_b32 s3, 12, s3
    s_cmp_eq_u32 s73, 15
    s_cselect_b32 s3, 18, s3
    s_cmp_eq_u32 s73, 17
    s_cselect_b32 s3, 6, s3
    s_cmp_eq_u32 s73, 18
    s_cselect_b32 s3, 12, s3
    s_cmp_eq_u32 s73, 19
    s_cselect_b32 s3, 18, s3
    s_cmp_eq_u32 s73, 21
    s_cselect_b32 s3, 6, s3
    s_cmp_eq_u32 s73, 22
    s_cselect_b32 s3, 12, s3
    s_cmp_eq_u32 s73, 23
    s_cselect_b32 s3, 18, s3
    s_cmp_eq_u32 s73, 25
    s_cselect_b32 s3, 6, s3
    s_cmp_eq_u32 s73, 26
    s_cselect_b32 s3, 12, s3
    s_cmp_eq_u32 s73, 27
    s_cselect_b32 s3, 18, s3
    s_cmp_eq_u32 s73, 29
    s_cselect_b32 s3, 6, s3
    s_cmp_eq_u32 s73, 30
    s_cselect_b32 s3, 12, s3
    s_cmp_eq_u32 s73, 31
    s_cselect_b32 s3, 18, s3
    s_cmp_lg_u32 s3, 0
    s_cbranch_scc1 L_p10
    s_waitcnt vmcnt(0)
    s_barrier
    s_barrier
L_p10:
    buffer_load_dwordx4 a[0:3], v2, s[4:7], s79 offen offset:0
    buffer_load_dwordx4 a[4:7], v2, s[4:7], s79 offen offset:64
    buffer_load_dwordx4 a[8:11], v2, s[4:7], s79 offen offset:128
    buffer_load_dwordx4 a[12:15], v2, s[4:7], s79 offen offset:192
    buffer_load_dwordx4 a[16:19], v2, s[4:7], s79 offen offset:256
    buffer_load_dwordx4 a[20:23], v2, s[4:7], s79 offen offset:320
    s_cmp_lg_u32 s3, 6
    s_cbranch_scc1 L_p16
    s_waitcnt vmcnt(0)
    s_barrier
    s_barrier
L_p16:
    buffer_load_dwordx4 a[24:27], v2, s[4:7], s79 offen offset:384
    buffer_load_dwordx4 a[28:31], v2, s[4:7], s79 offen offset:448
    v_lshrrev_b32 v9, 5, v1
    v_and_b32 v10, 31, v1
    v_add_u32 v11, 0, v9
    v_lshlrev_b32 v11, 1, v11
    v_xor_b32 v11, v11, v10
    v_lshlrev_b32 v11, 4, v11
    v_lshl_add_u32 v120, v9, 9, v11
    v_add_u32 v11, 2, v9
    v_lshlrev_b32 v11, 1, v11
    v_xor_b32 v11, v11, v10
    v_lshlrev_b32 v11, 4, v11
    v_lshl_add_u32 v121, v9, 9, v11
    v_add_u32 v11, 4, v9
    v_lshlrev_b32 v11, 1, v11
    v_xor_b32 v11, v11, v10
    v_lshlrev_b32 v11, 4, v11
    v_lshl_add_u32 v122, v9, 9, v11
    v_add_u32 v11, 6, v9
    v_lshlrev_b32 v11, 1, v11
    v_xor_b32 v11, v11, v10
    v_lshlrev_b32 v11, 4, v11
    v_lshl_add_u32 v123, v9, 9, v11
    s_lshl_b32 s78, s74, 15
    s_add_u32 s78, s78, 32768
    s_add_u32 s79, s79, 8192
    buffer_load_dwordx4 a[32:35], v2, s[4:7], s79 offen offset:0
    buffer_load_dwordx4 a[36:39], v2, s[4:7], s79 offen offset:64
    buffer_load_dwordx4 a[40:43], v2, s[4:7], s79 offen offset:128
    buffer_load_dwordx4 a[44:47], v2, s[4:7], s79 offen offset:192
    s_cmp_lg_u32 s3, 12
    s_cbranch_scc1 L_p112
    s_waitcnt vmcnt(0)
    s_barrier
    s_barrier
L_p112:
    buffer_load_dwordx4 a[48:51], v2, s[4:7], s79 offen offset:256
    buffer_load_dwordx4 a[52:55], v2, s[4:7], s79 offen offset:320
    buffer_load_dwordx4 a[56:59], v2, s[4:7], s79 offen offset:384
    buffer_load_dwordx4 a[60:63], v2, s[4:7], s79 offen offset:448
    s_waitcnt vmcnt(15)
    s_add_u32 s79, s79, 8192
    buffer_load_dwordx4 a[64:67], v2, s[4:7], s79 offen offset:0
    s_waitcnt vmcnt(15)
    buffer_load_dwordx4 a[68:71], v2, s[4:7], s79 offen offset:64
    s_cmp_lg_u32 s3, 18
    s_cbranch_scc1 L_p118
    s_waitcnt vmcnt(0)
    s_barrier
    s_barrier
L_p118:
    s_waitcnt vmcnt(15)
    buffer_load_dwordx4 a[72:75], v2, s[4:7], s79 offen offset:128
    s_waitcnt vmcnt(15)
    buffer_load_dwordx4 a[76:79], v2, s[4:7], s79 offen offset:192
    s_waitcnt vmcnt(15)
    buffer_load_dwordx4 a[80:83], v2, s[4:7], s79 offen offset:256
    s_waitcnt vmcnt(15)
    buffer_load_dwordx4 a[84:87], v2, s[4:7], s79 offen offset:320
    s_waitcnt vmcnt(15)
    buffer_load_dwordx4 a[88:91], v2, s[4:7], s79 offen offset:384
    s_waitcnt vmcnt(15)
    buffer_load_dwordx4 a[92:95], v2, s[4:7], s79 offen offset:448
    s_waitcnt vmcnt(15)
    s_add_u32 s79, s79, 8192
    buffer_load_dwordx4 a[96:99], v2, s[4:7], s79 offen offset:0
    s_waitcnt vmcnt(15)
    buffer_load_dwordx4 a[100:103], v2, s[4:7], s79 offen offset:64
    s_waitcnt vmcnt(15)
    buffer_load_dwordx4 a[104:107], v2, s[4:7], s79 offen offset:128
    s_waitcnt vmcnt(15)
    buffer_load_dwordx4 a[108:111], v2, s[4:7], s79 offen offset:192
    s_waitcnt vmcnt(15)
    buffer_load_dwordx4 a[112:115], v2, s[4:7], s79 offen offset:256
    s_waitcnt vmcnt(15)
    buffer_load_dwordx4 a[116:119], v2, s[4:7], s79 offen offset:320
    s_waitcnt vmcnt(15)
    buffer_load_dwordx4 a[120:123], v2, s[4:7], s79 offen offset:384
    s_waitcnt vmcnt(15)
    buffer_load_dwordx4 a[124:127], v2, s[4:7], s79 offen offset:448
    s_cmp_lg_u32 s88, 32
    s_cbranch_scc1 L_pz32
    s_waitcnt vmcnt(0)
    s_barrier
    s_barrier
L_pz32:
    s_waitcnt vmcnt(15)
    s_mov_b32 m0, s78
    s_add_u32 s78, s78, 1024
    buffer_load_dwordx4 v120, s[8:11], s80 offen lds
    s_add_u32 s80, s80, 1024
    s_waitcnt vmcnt(15)
    s_mov_b32 m0, s78
    s_add_u32 s78, s78, 1024
    buffer_load_dwordx4 v121, s[8:11], s80 offen lds
    s_add_u32 s80, s80, 1024
    s_waitcnt vmcnt(15)
    s_mov_b32 m0, s78
    s_add_u32 s78, s78, 1024
    buffer_load_dwordx4 v122, s[8:11], s80 offen lds
    s_add_u32 s80, s80, 1024
    s_waitcnt vmcnt(15)
    s_mov_b32 m0, s78
    s_add_u32 s78, s78, 1024
    buffer_load_dwordx4 v123, s[8:11], s80 offen lds
    s_add_u32 s80, s80, 1024
    s_waitcnt vmcnt(15)
    s_mov_b32 m0, s78
    s_add_u32 s78, s78, 1024
    buffer_load_dwordx4 v120, s[8:11], s80 offen lds
    s_add_u32 s80, s80, 1024
    s_waitcnt vmcnt(15)
    s_mov_b32 m0, s78
    s_add_u32 s78, s78, 1024
    buffer_load_dwordx4 v121, s[8:11], s80 offen lds
    s_add_u32 s80, s80, 1024
    s_cmp_lg_u32 s88, 38
    s_cbranch_scc1 L_pz38
    s_waitcnt vmcnt(0)
    s_barrier
    s_barrier
L_pz38:
    s_waitcnt vmcnt(15)
    s_mov_b32 m0, s78
    s_add_u32 s78, s78, 1024
    buffer_load_dwordx4 v122, s[8:11], s80 offen lds
    s_add_u32 s80, s80, 1024
    s_waitcnt vmcnt(15)
    s_mov_b32 m0, s78
    s_add_u32 s78, s78, 1024
    buffer_load_dwordx4 v123, s[8:11], s80 offen lds
    s_add_u32 s80, s80, 1024
    s_waitcnt vmcnt(15)
    s_mov_b32 m0, s78
    s_add_u32 s78, s78, 1024
    buffer_load_dwordx4 v120, s[8:11], s80 offen lds
    s_add_u32 s80, s80, 1024
    s_waitcnt vmcnt(15)
    s_mov_b32 m0, s78
    s_add_u32 s78, s78, 1024
    buffer_load_dwordx4 v121, s[8:11], s80 offen lds
    s_add_u32 s80, s80, 1024
    s_waitcnt vmcnt(15)
    s_mov_b32 m0, s78
    s_add_u32 s78, s78, 1024
    buffer_load_dwordx4 v122, s[8:11], s80 offen lds
    s_add_u32 s80, s80, 1024
    s_waitcnt vmcnt(15)
    s_mov_b32 m0, s78
    s_add_u32 s78, s78, 1024
    buffer_load_dwordx4 v123, s[8:11], s80 offen lds
    s_add_u32 s80, s80, 1024
    s_cmp_lg_u32 s88, 44
    s_cbranch_scc1 L_pz44
    s_waitcnt vmcnt(0)
    s_barrier
    s_barrier
L_pz44:
    s_waitcnt vmcnt(15)
    s_mov_b32 m0, s78
    s_add_u32 s78, s78, 1024
    buffer_load_dwordx4 v120, s[8:11], s80 offen lds
    s_add_u32 s80, s80, 1024
    s_waitcnt vmcnt(15)
    s_mov_b32 m0, s78
    s_add_u32 s78, s78, 1024
    buffer_load_dwordx4 v121, s[8:11], s80 offen lds
    s_add_u32 s80, s80, 1024
    s_waitcnt vmcnt(15)
    s_mov_b32 m0, s78
    s_add_u32 s78, s78, 1024
    buffer_load_dwordx4 v122, s[8:11], s80 offen lds
    s_add_u32 s80, s80, 1024
    s_waitcnt vmcnt(15)
    s_mov_b32 m0, s78
    s_add_u32 s78, s78, 1024
    buffer_load_dwordx4 v123, s[8:11], s80 offen lds
    s_add_u32 s80, s80, 1024
    s_waitcnt vmcnt(15)
    s_mov_b32 m0, s78
    s_add_u32 s78, s78, 1024
    buffer_load_dwordx4 v120, s[8:11], s80 offen lds
    s_add_u32 s80, s80, 1024
    s_waitcnt vmcnt(15)
    s_mov_b32 m0, s78
    s_add_u32 s78, s78, 1024
    buffer_load_dwordx4 v121, s[8:11], s80 offen lds
    s_add_u32 s80, s80, 1024
    s_cmp_lg_u32 s88, 50
    s_cbranch_scc1 L_pz50
    s_waitcnt vmcnt(0)
    s_barrier
    s_barrier
L_pz50:
    s_waitcnt vmcnt(15)
    s_mov_b32 m0, s78
    s_add_u32 s78, s78, 1024
    buffer_load_dwordx4 v122, s[8:11], s80 offen lds
    s_add_u32 s80, s80, 1024
    s_waitcnt vmcnt(15)
    s_mov_b32 m0, s78
    s_add_u32 s78, s78, 1024
    buffer_load_dwordx4 v123, s[8:11], s80 offen lds
    s_add_u32 s80, s80, 1024
    s_waitcnt vmcnt(15)
    s_mov_b32 m0, s78
    s_add_u32 s78, s78, 1024
    buffer_load_dwordx4 v120, s[8:11], s80 offen lds
    s_add_u32 s80, s80, 1024
    s_waitcnt vmcnt(15)
    s_mov_b32 m0, s78
    s_add_u32 s78, s78, 1024
    buffer_load_dwordx4 v121, s[8:11], s80 offen lds
    s_add_u32 s80, s80, 1024
    s_waitcnt vmcnt(15)
    s_mov_b32 m0, s78
    s_add_u32 s78, s78, 1024
    buffer_load_dwordx4 v122, s[8:11], s80 offen lds
    s_add_u32 s80, s80, 1024
    s_waitcnt vmcnt(15)
    s_mov_b32 m0, s78
    s_add_u32 s78, s78, 1024
    buffer_load_dwordx4 v123, s[8:11], s80 offen lds
    s_add_u32 s80, s80, 1024
    s_waitcnt vmcnt(15)
    s_mov_b32 m0, s78
    s_add_u32 s78, s78, 1024
    buffer_load_dwordx4 v120, s[8:11], s80 offen lds
    s_add_u32 s80, s80, 1024
    s_waitcnt vmcnt(15)
    s_mov_b32 m0, s78
    s_add_u32 s78, s78, 1024
    buffer_load_dwordx4 v121, s[8:11], s80 offen lds
    s_add_u32 s80, s80, 1024
    s_waitcnt vmcnt(15)
    s_mov_b32 m0, s78
    s_add_u32 s78, s78, 1024
    buffer_load_dwordx4 v122, s[8:11], s80 offen lds
    s_add_u32 s80, s80, 1024
    s_waitcnt vmcnt(15)
    s_mov_b32 m0, s78
    s_add_u32 s78, s78, 1024
    buffer_load_dwordx4 v123, s[8:11], s80 offen lds
    s_add_u32 s80, s80, 1024
    s_waitcnt vmcnt(15)
    s_mov_b32 m0, s78
    s_add_u32 s78, s78, 1024
    buffer_load_dwordx4 v120, s[8:11], s80 offen lds
    s_add_u32 s80, s80, 1024
    s_waitcnt vmcnt(15)
    s_mov_b32 m0, s78
    s_add_u32 s78, s78, 1024
    buffer_load_dwordx4 v121, s[8:11], s80 offen lds
    s_add_u32 s80, s80, 1024
    s_waitcnt vmcnt(15)
    s_mov_b32 m0, s78
    s_add_u32 s78, s78, 1024
    buffer_load_dwordx4 v122, s[8:11], s80 offen lds
    s_add_u32 s80, s80, 1024
    s_waitcnt vmcnt(15)
    s_mov_b32 m0, s78
    s_add_u32 s78, s78, 1024
    buffer_load_dwordx4 v123, s[8:11], s80 offen lds
    s_add_u32 s80, s80, 1024
    v_mov_b32 v32, 0
    v_mov_b32 v33, 0
    v_mov_b32 v34, 0
    v_mov_b32 v35, 0
    v_mov_b32 v36, 0
    v_mov_b32 v37, 0
    v_mov_b32 v38, 0
    v_mov_b32 v39, 0
    v_mov_b32 v40, 0
    v_mov_b32 v41, 0
    v_mov_b32 v42, 0
    v_mov_b32 v43, 0
    v_mov_b32 v44, 0
    v_mov_b32 v45, 0
    v_mov_b32 v46, 0
    v_mov_b32 v47, 0
    v_mov_b32 v48, 0
    v_mov_b32 v49, 0
    v_mov_b32 v50, 0
    v_mov_b32 v51, 0
    v_mov_b32 v52, 0
    v_mov_b32 v53, 0
    v_mov_b32 v54, 0
    v_mov_b32 v55, 0
    v_mov_b32 v56, 0
    v_mov_b32 v57, 0
    v_mov_b32 v58, 0
    v_mov_b32 v59, 0
    v_mov_b32 v60, 0
    v_mov_b32 v61, 0
    v_mov_b32 v62, 0
    v_mov_b32 v63, 0
    v_and_b32 v9, 15, v1
    v_lshrrev_b32 v10, 2, v9
    v_lshl_add_u32 v10, v7, 2, v10
    v_and_b32 v11, 7, v10
    v_and_b32 v9, 3, v9
    v_lshlrev_b32 v10, 9, v10
    v_lshl_add_u32 v10, v9, 3, v10
    s_lshl_b32 s75, s74, 15
    s_add_u32 s75, s75, 32768
    v_add_u32 v10, s75, v10
    v_xor_b32 v9, 0, v11
    v_lshl_add_u32 v112, v9, 5, v10
    v_xor_b32 v9, 1, v11
    v_lshl_add_u32 v113, v9, 5, v10
    v_xor_b32 v9, 2, v11
    v_lshl_add_u32 v114, v9, 5, v10
    v_xor_b32 v9, 3, v11
    v_lshl_add_u32 v115, v9, 5, v10
    v_xor_b32 v9, 4, v11
    v_lshl_add_u32 v116, v9, 5, v10
    v_xor_b32 v9, 5, v11
    v_lshl_add_u32 v117, v9, 5, v10
    v_xor_b32 v9, 6, v11
    v_lshl_add_u32 v118, v9, 5, v10
    v_xor_b32 v9, 7, v11
    v_lshl_add_u32 v119, v9, 5, v10
    v_and_b32 v6, 15, v1
    v_cmp_gt_u32 vcc, 2, v6
    s_nop 0
    s_and_saveexec_b64 s[98:99], vcc
    ds_read_b128 v[32:35], v2 offset:2048
    ds_read_b128 v[36:39], v2 offset:2112
    ds_read_b128 v[40:43], v2 offset:2176
    ds_read_b128 v[44:47], v2 offset:2240
    ds_read_b128 v[48:51], v2 offset:2304
    ds_read_b128 v[52:55], v2 offset:2368
    ds_read_b128 v[56:59], v2 offset:2432
    ds_read_b128 v[60:63], v2 offset:2496
    s_mov_b64 exec, s[98:99]
    s_waitcnt vmcnt(32) lgkmcnt(0)
    v_mfma_f32_16x16x32_bf16 v[16:19], a[0:3], v[32:35], 0
    v_mfma_f32_16x16x32_bf16 v[16:19], a[4:7], v[36:39], v[16:19]
    v_mfma_f32_16x16x32_bf16 v[16:19], a[8:11], v[40:43], v[16:19]
    v_mfma_f32_16x16x32_bf16 v[16:19], a[12:15], v[44:47], v[16:19]
    v_mfma_f32_16x16x32_bf16 v[16:19], a[16:19], v[48:51], v[16:19]
    v_mfma_f32_16x16x32_bf16 v[16:19], a[20:23], v[52:55], v[16:19]
    v_mfma_f32_16x16x32_bf16 v[16:19], a[24:27], v[56:59], v[16:19]
    v_mfma_f32_16x16x32_bf16 v[16:19], a[28:31], v[60:63], v[16:19]
    v_mfma_f32_16x16x32_bf16 v[20:23], a[32:35], v[32:35], 0
    v_mfma_f32_16x16x32_bf16 v[20:23], a[36:39], v[36:39], v[20:23]
    v_mfma_f32_16x16x32_bf16 v[20:23], a[40:43], v[40:43], v[20:23]
    v_mfma_f32_16x16x32_bf16 v[20:23], a[44:47], v[44:47], v[20:23]
    v_mfma_f32_16x16x32_bf16 v[20:23], a[48:51], v[48:51], v[20:23]
    v_mfma_f32_16x16x32_bf16 v[20:23], a[52:55], v[52:55], v[20:23]
    v_mfma_f32_16x16x32_bf16 v[20:23], a[56:59], v[56:59], v[20:23]
    v_mfma_f32_16x16x32_bf16 v[20:23], a[60:63], v[60:63], v[20:23]
    v_mfma_f32_16x16x32_bf16 v[24:27], a[64:67], v[32:35], 0
    v_mfma_f32_16x16x32_bf16 v[24:27], a[68:71], v[36:39], v[24:27]
    v_mfma_f32_16x16x32_bf16 v[24:27], a[72:75], v[40:43], v[24:27]
    v_mfma_f32_16x16x32_bf16 v[24:27], a[76:79], v[44:47], v[24:27]
    v_mfma_f32_16x16x32_bf16 v[24:27], a[80:83], v[48:51], v[24:27]
    v_mfma_f32_16x16x32_bf16 v[24:27], a[84:87], v[52:55], v[24:27]
    v_mfma_f32_16x16x32_bf16 v[24:27], a[88:91], v[56:59], v[24:27]
    v_mfma_f32_16x16x32_bf16 v[24:27], a[92:95], v[60:63], v[24:27]
    v_mfma_f32_16x16x32_bf16 v[28:31], a[96:99], v[32:35], 0
    v_mfma_f32_16x16x32_bf16 v[28:31], a[100:103], v[36:39], v[28:31]
    v_mfma_f32_16x16x32_bf16 v[28:31], a[104:107], v[40:43], v[28:31]
    v_mfma_f32_16x16x32_bf16 v[28:31], a[108:111], v[44:47], v[28:31]
    v_mfma_f32_16x16x32_bf16 v[28:31], a[112:115], v[48:51], v[28:31]
    v_mfma_f32_16x16x32_bf16 v[28:31], a[116:119], v[52:55], v[28:31]
    v_mfma_f32_16x16x32_bf16 v[28:31], a[120:123], v[56:59], v[28:31]
    v_mfma_f32_16x16x32_bf16 v[28:31], a[124:127], v[60:63], v[28:31]
    v_cvt_pk_bf16_f32 v9, v16, v17
    v_lshlrev_b32 v16, 16, v9
    v_and_b32 v17, 0xffff0000, v9
    v_cvt_pk_bf16_f32 v9, v18, v19
    v_lshlrev_b32 v18, 16, v9
    v_and_b32 v19, 0xffff0000, v9
    v_cvt_pk_bf16_f32 v9, v20, v21
    v_lshlrev_b32 v20, 16, v9
    v_and_b32 v21, 0xffff0000, v9
    v_cvt_pk_bf16_f32 v9, v22, v23
    v_lshlrev_b32 v22, 16, v9
    v_and_b32 v23, 0xffff0000, v9
    v_cvt_pk_bf16_f32 v9, v24, v25
    v_lshlrev_b32 v24, 16, v9
    v_and_b32 v25, 0xffff0000, v9
    v_cvt_pk_bf16_f32 v9, v26, v27
    v_lshlrev_b32 v26, 16, v9
    v_and_b32 v27, 0xffff0000, v9
    v_cvt_pk_bf16_f32 v9, v28, v29
    v_lshlrev_b32 v28, 16, v9
    v_and_b32 v29, 0xffff0000, v9
    v_cvt_pk_bf16_f32 v9, v30, v31
    v_lshlrev_b32 v30, 16, v9
    v_and_b32 v31, 0xffff0000, v9
    v_mul_f32 v16, 0x3db8aa3b, v16
    v_mul_f32 v17, 0x3db8aa3b, v17
    v_mul_f32 v18, 0x3db8aa3b, v18
    v_mul_f32 v19, 0x3db8aa3b, v19
    v_mul_f32 v20, 0x3db8aa3b, v20
    v_mul_f32 v21, 0x3db8aa3b, v21
    v_mul_f32 v22, 0x3db8aa3b, v22
    v_mul_f32 v23, 0x3db8aa3b, v23
    v_mul_f32 v24, 0x3db8aa3b, v24
    v_mul_f32 v25, 0x3db8aa3b, v25
    v_mul_f32 v26, 0x3db8aa3b, v26
    v_mul_f32 v27, 0x3db8aa3b, v27
    v_mul_f32 v28, 0x3db8aa3b, v28
    v_mul_f32 v29, 0x3db8aa3b, v29
    v_mul_f32 v30, 0x3db8aa3b, v30
    v_mul_f32 v31, 0x3db8aa3b, v31
    v_max_f32 v9, v16, v17
    v_max3_f32 v9, v9, v18, v19
    v_max3_f32 v9, v9, v20, v21
    v_max3_f32 v9, v9, v22, v23
    v_max3_f32 v9, v9, v24, v25
    v_max3_f32 v9, v9, v26, v27
    v_max3_f32 v9, v9, v28, v29
    v_max3_f32 v9, v9, v30, v31
    v_mov_b32 v10, v9
    s_nop 1
    v_permlane16_swap_b32 v9, v10
    v_max_f32 v9, v9, v10
    v_mov_b32 v10, v9
    s_nop 1
    v_permlane32_swap_b32 v9, v10
    v_max_f32 v9, v9, v10
    v_sub_f32 v16, v16, v9
    v_sub_f32 v17, v17, v9
    v_sub_f32 v18, v18, v9
    v_sub_f32 v19, v19, v9
    v_sub_f32 v20, v20, v9
    v_sub_f32 v21, v21, v9
    v_sub_f32 v22, v22, v9
    v_sub_f32 v23, v23, v9
    v_sub_f32 v24, v24, v9
    v_sub_f32 v25, v25, v9
    v_sub_f32 v26, v26, v9
    v_sub_f32 v27, v27, v9
    v_sub_f32 v28, v28, v9
    v_sub_f32 v29, v29, v9
    v_sub_f32 v30, v30, v9
    v_sub_f32 v31, v31, v9
    v_exp_f32 v16, v16
    v_exp_f32 v17, v17
    v_exp_f32 v18, v18
    v_exp_f32 v19, v19
    v_exp_f32 v20, v20
    v_exp_f32 v21, v21
    v_exp_f32 v22, v22
    v_exp_f32 v23, v23
    v_exp_f32 v24, v24
    v_exp_f32 v25, v25
    v_exp_f32 v26, v26
    v_exp_f32 v27, v27
    v_exp_f32 v28, v28
    v_exp_f32 v29, v29
    v_exp_f32 v30, v30
    v_exp_f32 v31, v31
    v_cvt_pk_bf16_f32 v104, v16, v17
    v_cvt_pk_bf16_f32 v105, v18, v19
    v_cvt_pk_bf16_f32 v106, v20, v21
    v_cvt_pk_bf16_f32 v107, v22, v23
    v_cvt_pk_bf16_f32 v108, v24, v25
    v_cvt_pk_bf16_f32 v109, v26, v27
    v_cvt_pk_bf16_f32 v110, v28, v29
    v_cvt_pk_bf16_f32 v111, v30, v31
    v_lshlrev_b32 v11, 16, v104
    v_and_b32 v12, 0xffff0000, v104
    v_add_f32 v11, v11, v12
    v_lshlrev_b32 v12, 16, v105
    v_add_f32 v11, v11, v12
    v_and_b32 v12, 0xffff0000, v105
    v_add_f32 v11, v11, v12
    v_lshlrev_b32 v12, 16, v106
    v_add_f32 v11, v11, v12
    v_and_b32 v12, 0xffff0000, v106
    v_add_f32 v11, v11, v12
    v_lshlrev_b32 v12, 16, v107
    v_add_f32 v11, v11, v12
    v_and_b32 v12, 0xffff0000, v107
    v_add_f32 v11, v11, v12
    v_lshlrev_b32 v12, 16, v108
    v_add_f32 v11, v11, v12
    v_and_b32 v12, 0xffff0000, v108
    v_add_f32 v11, v11, v12
    v_lshlrev_b32 v12, 16, v109
    v_add_f32 v11, v11, v12
    v_and_b32 v12, 0xffff0000, v109
    v_add_f32 v11, v11, v12
    v_lshlrev_b32 v12, 16, v110
    v_add_f32 v11, v11, v12
    v_and_b32 v12, 0xffff0000, v110
    v_add_f32 v11, v11, v12
    v_lshlrev_b32 v12, 16, v111
    v_add_f32 v11, v11, v12
    v_and_b32 v12, 0xffff0000, v111
    v_add_f32 v11, v11, v12
    v_mov_b32 v10, v11
    s_nop 1
    v_permlane16_swap_b32 v11, v10
    v_add_f32 v11, v11, v10
    v_mov_b32 v10, v11
    s_nop 1
    v_permlane32_swap_b32 v11, v10
    v_add_f32 v11, v11, v10
    v_and_b32 v12, 15, v1
    v_lshlrev_b32 v12, 2, v12
    s_lshl_b32 s76, s74, 4
    v_add_u32 v12, s76, v12
    s_and_saveexec_b64 s[98:99], vcc
    ds_write_b32 v12, v9 offset:14336
    ds_write_b32 v12, v11 offset:14344
    s_mov_b64 exec, s[98:99]
    s_waitcnt vmcnt(16) lgkmcnt(0)
    ds_read_b64_tr_b16 v[32:33], v112 offset:0
    ds_read_b64_tr_b16 v[34:35], v112 offset:8192
    ds_read_b64_tr_b16 v[36:37], v113 offset:0
    ds_read_b64_tr_b16 v[38:39], v113 offset:8192
    s_waitcnt lgkmcnt(2)
    v_mfma_f32_16x16x32_bf16 v[40:43], v[32:35], v[104:107], 0
    ds_read_b64_tr_b16 v[32:33], v114 offset:0
    ds_read_b64_tr_b16 v[34:35], v114 offset:8192
    s_waitcnt lgkmcnt(2)
    v_mfma_f32_16x16x32_bf16 v[44:47], v[36:39], v[104:107], 0
    ds_read_b64_tr_b16 v[36:37], v115 offset:0
    ds_read_b64_tr_b16 v[38:39], v115 offset:8192
    s_waitcnt lgkmcnt(2)
    v_mfma_f32_16x16x32_bf16 v[48:51], v[32:35], v[104:107], 0
    ds_read_b64_tr_b16 v[32:33], v116 offset:0
    ds_read_b64_tr_b16 v[34:35], v116 offset:8192
    s_waitcnt lgkmcnt(2)
    v_mfma_f32_16x16x32_bf16 v[52:55], v[36:39], v[104:107], 0
    ds_read_b64_tr_b16 v[36:37], v117 offset:0
    ds_read_b64_tr_b16 v[38:39], v117 offset:8192
    s_waitcnt lgkmcnt(2)
    v_mfma_f32_16x16x32_bf16 v[56:59], v[32:35], v[104:107], 0
    ds_read_b64_tr_b16 v[32:33], v118 offset:0
    ds_read_b64_tr_b16 v[34:35], v118 offset:8192
    s_waitcnt lgkmcnt(2)
    v_mfma_f32_16x16x32_bf16 v[60:63], v[36:39], v[104:107], 0
    ds_read_b64_tr_b16 v[36:37], v119 offset:0
    ds_read_b64_tr_b16 v[38:39], v119 offset:8192
    s_waitcnt lgkmcnt(2)
    v_mfma_f32_16x16x32_bf16 v[64:67], v[32:35], v[104:107], 0
    ds_read_b64_tr_b16 v[32:33], v112 offset:256
    ds_read_b64_tr_b16 v[34:35], v112 offset:8448
    s_waitcnt lgkmcnt(2)
    v_mfma_f32_16x16x32_bf16 v[68:71], v[36:39], v[104:107], 0
    ds_read_b64_tr_b16 v[36:37], v113 offset:256
    ds_read_b64_tr_b16 v[38:39], v113 offset:8448
    s_waitcnt lgkmcnt(2)
    v_mfma_f32_16x16x32_bf16 v[72:75], v[32:35], v[104:107], 0
    ds_read_b64_tr_b16 v[32:33], v114 offset:256
    ds_read_b64_tr_b16 v[34:35], v114 offset:8448
    s_waitcnt lgkmcnt(2)
    v_mfma_f32_16x16x32_bf16 v[76:79], v[36:39], v[104:107], 0
    ds_read_b64_tr_b16 v[36:37], v115 offset:256
    ds_read_b64_tr_b16 v[38:39], v115 offset:8448
    s_waitcnt lgkmcnt(2)
    v_mfma_f32_16x16x32_bf16 v[80:83], v[32:35], v[104:107], 0
    ds_read_b64_tr_b16 v[32:33], v116 offset:256
    ds_read_b64_tr_b16 v[34:35], v116 offset:8448
    s_waitcnt lgkmcnt(2)
    v_mfma_f32_16x16x32_bf16 v[84:87], v[36:39], v[104:107], 0
    ds_read_b64_tr_b16 v[36:37], v117 offset:256
    ds_read_b64_tr_b16 v[38:39], v117 offset:8448
    s_waitcnt lgkmcnt(2)
    v_mfma_f32_16x16x32_bf16 v[88:91], v[32:35], v[104:107], 0
    ds_read_b64_tr_b16 v[32:33], v118 offset:256
    ds_read_b64_tr_b16 v[34:35], v118 offset:8448
    s_waitcnt lgkmcnt(2)
    v_mfma_f32_16x16x32_bf16 v[92:95], v[36:39], v[104:107], 0
    ds_read_b64_tr_b16 v[36:37], v119 offset:256
    ds_read_b64_tr_b16 v[38:39], v119 offset:8448
    s_waitcnt lgkmcnt(2)
    v_mfma_f32_16x16x32_bf16 v[96:99], v[32:35], v[104:107], 0
    s_waitcnt lgkmcnt(0)
    v_mfma_f32_16x16x32_bf16 v[100:103], v[36:39], v[104:107], 0
    s_waitcnt vmcnt(0)
    ds_read_b64_tr_b16 v[32:33], v112 offset:16384
    ds_read_b64_tr_b16 v[34:35], v112 offset:24576
    ds_read_b64_tr_b16 v[36:37], v113 offset:16384
    ds_read_b64_tr_b16 v[38:39], v113 offset:24576
    s_waitcnt lgkmcnt(2)
    v_mfma_f32_16x16x32_bf16 v[40:43], v[32:35], v[108:111], v[40:43]
    ds_read_b64_tr_b16 v[32:33], v114 offset:16384
    ds_read_b64_tr_b16 v[34:35], v114 offset:24576
    s_waitcnt lgkmcnt(2)
    v_mfma_f32_16x16x32_bf16 v[44:47], v[36:39], v[108:111], v[44:47]
    ds_read_b64_tr_b16 v[36:37], v115 offset:16384
    ds_read_b64_tr_b16 v[38:39], v115 offset:24576
    s_waitcnt lgkmcnt(2)
    v_mfma_f32_16x16x32_bf16 v[48:51], v[32:35], v[108:111], v[48:51]
    ds_read_b64_tr_b16 v[32:33], v116 offset:16384
    ds_read_b64_tr_b16 v[34:35], v116 offset:24576
    s_waitcnt lgkmcnt(2)
    v_mfma_f32_16x16x32_bf16 v[52:55], v[36:39], v[108:111], v[52:55]
    ds_read_b64_tr_b16 v[36:37], v117 offset:16384
    ds_read_b64_tr_b16 v[38:39], v117 offset:24576
    s_waitcnt lgkmcnt(2)
    v_mfma_f32_16x16x32_bf16 v[56:59], v[32:35], v[108:111], v[56:59]
    ds_read_b64_tr_b16 v[32:33], v118 offset:16384
    ds_read_b64_tr_b16 v[34:35], v118 offset:24576
    s_waitcnt lgkmcnt(2)
    v_mfma_f32_16x16x32_bf16 v[60:63], v[36:39], v[108:111], v[60:63]
    ds_read_b64_tr_b16 v[36:37], v119 offset:16384
    ds_read_b64_tr_b16 v[38:39], v119 offset:24576
    s_waitcnt lgkmcnt(2)
    v_mfma_f32_16x16x32_bf16 v[64:67], v[32:35], v[108:111], v[64:67]
    ds_read_b64_tr_b16 v[32:33], v112 offset:16640
    ds_read_b64_tr_b16 v[34:35], v112 offset:24832
    s_waitcnt lgkmcnt(2)
    v_mfma_f32_16x16x32_bf16 v[68:71], v[36:39], v[108:111], v[68:71]
    ds_read_b64_tr_b16 v[36:37], v113 offset:16640
    ds_read_b64_tr_b16 v[38:39], v113 offset:24832
    s_waitcnt lgkmcnt(2)
    v_mfma_f32_16x16x32_bf16 v[72:75], v[32:35], v[108:111], v[72:75]
    ds_read_b64_tr_b16 v[32:33], v114 offset:16640
    ds_read_b64_tr_b16 v[34:35], v114 offset:24832
    s_waitcnt lgkmcnt(2)
    v_mfma_f32_16x16x32_bf16 v[76:79], v[36:39], v[108:111], v[76:79]
    ds_read_b64_tr_b16 v[36:37], v115 offset:16640
    ds_read_b64_tr_b16 v[38:39], v115 offset:24832
    s_waitcnt lgkmcnt(2)
    v_mfma_f32_16x16x32_bf16 v[80:83], v[32:35], v[108:111], v[80:83]
    ds_read_b64_tr_b16 v[32:33], v116 offset:16640
    ds_read_b64_tr_b16 v[34:35], v116 offset:24832
    s_waitcnt lgkmcnt(2)
    v_mfma_f32_16x16x32_bf16 v[84:87], v[36:39], v[108:111], v[84:87]
    ds_read_b64_tr_b16 v[36:37], v117 offset:16640
    ds_read_b64_tr_b16 v[38:39], v117 offset:24832
    s_waitcnt lgkmcnt(2)
    v_mfma_f32_16x16x32_bf16 v[88:91], v[32:35], v[108:111], v[88:91]
    ds_read_b64_tr_b16 v[32:33], v118 offset:16640
    ds_read_b64_tr_b16 v[34:35], v118 offset:24832
    s_waitcnt lgkmcnt(2)
    v_mfma_f32_16x16x32_bf16 v[92:95], v[36:39], v[108:111], v[92:95]
    ds_read_b64_tr_b16 v[36:37], v119 offset:16640
    ds_read_b64_tr_b16 v[38:39], v119 offset:24832
    s_waitcnt lgkmcnt(2)
    v_mfma_f32_16x16x32_bf16 v[96:99], v[32:35], v[108:111], v[96:99]
    s_waitcnt lgkmcnt(0)
    v_mfma_f32_16x16x32_bf16 v[100:103], v[36:39], v[108:111], v[100:103]
    v_and_b32 v12, 15, v1
    v_lshlrev_b32 v12, 10, v12
    v_lshl_add_u32 v12, v7, 4, v12
    s_lshl_b32 s75, s74, 11
    v_add_u32 v12, s75, v12
    s_and_saveexec_b64 s[98:99], vcc
    ds_write_b128 v12, v[40:43] offset:6144
    ds_write_b128 v12, v[44:47] offset:6208
    ds_write_b128 v12, v[48:51] offset:6272
    ds_write_b128 v12, v[52:55] offset:6336
    ds_write_b128 v12, v[56:59] offset:6400
    ds_write_b128 v12, v[60:63] offset:6464
    ds_write_b128 v12, v[64:67] offset:6528
    ds_write_b128 v12, v[68:71] offset:6592
    ds_write_b128 v12, v[72:75] offset:6656
    ds_write_b128 v12, v[76:79] offset:6720
    ds_write_b128 v12, v[80:83] offset:6784
    ds_write_b128 v12, v[84:87] offset:6848
    ds_write_b128 v12, v[88:91] offset:6912
    ds_write_b128 v12, v[92:95] offset:6976
    ds_write_b128 v12, v[96:99] offset:7040
    ds_write_b128 v12, v[100:103] offset:7104
    s_mov_b64 exec, s[98:99]
    v_mov_b32 v13, 0
    v_mov_b32 v14, 1
    s_waitcnt lgkmcnt(0)
    s_mov_b64 exec, 1
    ds_add_u32 v13, v14 offset:19552
    s_mov_b64 exec, -1
    s_cmp_ge_u32 s74, 2
    s_cbranch_scc1 L_nopub
L_b3spin:
    ds_read_b32 v14, v13 offset:19552
    s_waitcnt lgkmcnt(0)
    v_cmp_gt_u32 vcc, 4, v14
    s_nop 1
    s_cbranch_vccz L_b3ok
    s_add_u32 s89, s89, 1
    s_cmp_gt_u32 s89, 100000
    s_cbranch_scc1 L_b3ok
    s_branch L_b3spin
L_b3ok:
    s_lshl_b32 s75, s74, 2
    v_mov_b32 v12, s75
    ds_read_b32 v16, v12 offset:14336
    ds_read_b32 v20, v12 offset:14344
    ds_read_b32 v17, v12 offset:14352
    ds_read_b32 v21, v12 offset:14360
    ds_read_b32 v18, v12 offset:14368
    ds_read_b32 v22, v12 offset:14376
    ds_read_b32 v19, v12 offset:14384
    ds_read_b32 v23, v12 offset:14392
    s_lshl_b32 s75, s74, 10
    v_add_u32 v13, s75, v3
    ds_read_b128 v[32:35], v13 offset:6144
    ds_read_b128 v[36:39], v13 offset:8192
    ds_read_b128 v[40:43], v13 offset:10240
    ds_read_b128 v[44:47], v13 offset:12288
    s_waitcnt lgkmcnt(4)
    v_max_f32 v10, v16, v17
    v_max3_f32 v10, v10, v18, v19
    v_sub_f32 v16, v16, v10
    v_sub_f32 v17, v17, v10
    v_sub_f32 v18, v18, v10
    v_sub_f32 v19, v19, v10
    v_exp_f32 v16, v16
    v_exp_f32 v17, v17
    v_exp_f32 v18, v18
    v_exp_f32 v19, v19
    v_mul_f32 v11, v16, v20
    v_fmac_f32 v11, v17, v21
    v_fmac_f32 v11, v18, v22
    v_fmac_f32 v11, v19, v23
    s_waitcnt lgkmcnt(0)
    v_mul_f32 v24, v32, v16
    v_mul_f32 v25, v33, v16
    v_mul_f32 v26, v34, v16
    v_mul_f32 v27, v35, v16
    v_fmac_f32 v24, v36, v17
    v_fmac_f32 v25, v37, v17
    v_fmac_f32 v26, v38, v17
    v_fmac_f32 v27, v39, v17
    v_fmac_f32 v24, v40, v18
    v_fmac_f32 v25, v41, v18
    v_fmac_f32 v26, v42, v18
    v_fmac_f32 v27, v43, v18
    v_fmac_f32 v24, v44, v19
    v_fmac_f32 v25, v45, v19
    v_fmac_f32 v26, v46, v19
    v_fmac_f32 v27, v47, v19
    v_min_u32 v24, 0xfffffffe, v24
    v_min_u32 v25, 0xfffffffe, v25
    v_min_u32 v26, 0xfffffffe, v26
    v_min_u32 v27, 0xfffffffe, v27
    v_min_u32 v10, 0xfffffffe, v10
    v_min_u32 v11, 0xfffffffe, v11
    s_lshl_b32 s75, s72, 1
    s_add_u32 s75, s75, s74
    s_lshl_b32 s75, s75, 5
    s_add_u32 s75, s75, s73
    s_lshl_b32 s76, s75, 10
    s_add_u32 s76, s76, 16384
    buffer_store_dwordx4 v[24:27], v3, s[12:15], s76 offen sc1
    s_lshl_b32 s76, s75, 3
    s_add_u32 s76, s76, 8192
    v_cmp_eq_u32 vcc, 0, v1
    s_nop 1
    v_cndmask_b32 v13, v8, v1, vcc
    buffer_store_dwordx2 v[10:11], v13, s[12:15], s76 offen sc1
    v_mov_b32 v13, 0
    v_mov_b32 v14, 1
    s_waitcnt vmcnt(0)
    s_mov_b64 exec, 1
    ds_add_u32 v13, v14 offset:19552
    s_mov_b64 exec, -1
L_nopub:
    s_cmp_eq_u32 s87, 0
    s_cbranch_scc1 L_end
    v_mov_b32 v13, 0
L_b4spin:
    ds_read_b32 v14, v13 offset:19556
    s_waitcnt lgkmcnt(0)
    v_cmp_ne_u32 vcc, 1, v14
    s_nop 1
    s_cbranch_vccz L_b4ok
    s_add_u32 s89, s89, 1
    s_cmp_gt_u32 s89, 100000
    s_cbranch_scc1 L_b4ok
    s_sleep 1
    s_branch L_b4spin
L_b4ok:
    s_cmp_eq_u32 s87, 2
    s_cbranch_scc1 L_ffn
    s_cmp_eq_u32 s87, 3
    s_cbranch_scc1 L_fin
    v_lshlrev_b32 v9, 3, v7
    v_and_b32 v10, 15, v1
    v_lshlrev_b32 v10, 4, v10
    v_lshl_add_u32 v10, v7, 10, v10
    s_lshl_b32 s85, s81, 8
    s_add_u32 s85, s85, 8192
    s_lshl_b32 s86, s81, 15
    s_lshl_b32 s75, s74, 8
    s_add_u32 s86, s86, s75
    s_add_u32 s86, s86, 16384
    s_lshl_b32 s75, s74, 13
    v_add_u32 v12, s75, v3
    ds_read_b128 v[64:67], v12 offset:32768
    ds_read_b128 v[68:71], v12 offset:33792
    ds_read_b128 v[72:75], v12 offset:34816
    ds_read_b128 v[76:79], v12 offset:35840
    ds_read_b128 v[80:83], v12 offset:36864
    ds_read_b128 v[84:87], v12 offset:37888
    ds_read_b128 v[88:91], v12 offset:38912
    ds_read_b128 v[92:95], v12 offset:39936
    v_and_b32 v12, 31, v1
    v_lshlrev_b32 v12, 3, v12
L_wopre:
    buffer_load_dwordx2 v[16:17], v12, s[12:15], s85 offen sc1
    s_waitcnt vmcnt(0)
    v_max_u32 v11, v16, v17
    v_cmp_eq_u32 vcc, -1, v11
    s_nop 1
    s_cbranch_vccnz L_wopre2
    s_branch L_wore3
L_wopre2:
    s_add_u32 s89, s89, 1
    s_cmp_gt_u32 s89, 100000
    s_cbranch_scc1 L_wore3
    s_sleep 1
    s_branch L_wopre
L_wore3:
    buffer_load_dwordx2 v[16:17], v9, s[12:15], s85 offen offset:0 sc1
    buffer_load_dwordx2 v[18:19], v9, s[12:15], s85 offen offset:32 sc1
    buffer_load_dwordx2 v[20:21], v9, s[12:15], s85 offen offset:64 sc1
    buffer_load_dwordx2 v[22:23], v9, s[12:15], s85 offen offset:96 sc1
    buffer_load_dwordx2 v[24:25], v9, s[12:15], s85 offen offset:128 sc1
    buffer_load_dwordx2 v[26:27], v9, s[12:15], s85 offen offset:160 sc1
    buffer_load_dwordx2 v[28:29], v9, s[12:15], s85 offen offset:192 sc1
    buffer_load_dwordx2 v[30:31], v9, s[12:15], s85 offen offset:224 sc1
    s_mov_b32 s75, s86
    buffer_load_dwordx4 v[32:35], v10, s[12:15], s75 offen sc1
    s_add_u32 s75, s75, 4096
    buffer_load_dwordx4 v[36:39], v10, s[12:15], s75 offen sc1
    s_add_u32 s75, s75, 4096
    buffer_load_dwordx4 v[40:43], v10, s[12:15], s75 offen sc1
    s_add_u32 s75, s75, 4096
    buffer_load_dwordx4 v[44:47], v10, s[12:15], s75 offen sc1
    s_add_u32 s75, s75, 4096
    buffer_load_dwordx4 v[48:51], v10, s[12:15], s75 offen sc1
    s_add_u32 s75, s75, 4096
    buffer_load_dwordx4 v[52:55], v10, s[12:15], s75 offen sc1
    s_add_u32 s75, s75, 4096
    buffer_load_dwordx4 v[56:59], v10, s[12:15], s75 offen sc1
    s_add_u32 s75, s75, 4096
    buffer_load_dwordx4 v[60:63], v10, s[12:15], s75 offen sc1
L_wopoll:
    s_waitcnt vmcnt(0)
    v_max_u32 v11, v16, v17
    v_max3_u32 v11, v11, v18, v19
    v_max3_u32 v11, v11, v20, v21
    v_max3_u32 v11, v11, v22, v23
    v_max3_u32 v11, v11, v24, v25
    v_max3_u32 v11, v11, v26, v27
    v_max3_u32 v11, v11, v28, v29
    v_max3_u32 v11, v11, v30, v31
    v_max3_u32 v11, v11, v32, v33
    v_max3_u32 v11, v11, v34, v35
    v_max3_u32 v11, v11, v36, v37
    v_max3_u32 v11, v11, v38, v39
    v_max3_u32 v11, v11, v40, v41
    v_max3_u32 v11, v11, v42, v43
    v_max3_u32 v11, v11, v44, v45
    v_max3_u32 v11, v11, v46, v47
    v_max3_u32 v11, v11, v48, v49
    v_max3_u32 v11, v11, v50, v51
    v_max3_u32 v11, v11, v52, v53
    v_max3_u32 v11, v11, v54, v55
    v_max3_u32 v11, v11, v56, v57
    v_max3_u32 v11, v11, v58, v59
    v_max3_u32 v11, v11, v60, v61
    v_max3_u32 v11, v11, v62, v63
    v_cmp_eq_u32 vcc, -1, v11
    s_nop 1
    s_cbranch_vccnz L_wore
    s_branch L_wogo
L_wore:
    s_add_u32 s89, s89, 1
    s_cmp_gt_u32 s89, 100000
    s_cbranch_scc1 L_wogo
    s_sleep 1
    buffer_load_dwordx2 v[16:17], v9, s[12:15], s85 offen offset:0 sc1
    buffer_load_dwordx2 v[18:19], v9, s[12:15], s85 offen offset:32 sc1
    buffer_load_dwordx2 v[20:21], v9, s[12:15], s85 offen offset:64 sc1
    buffer_load_dwordx2 v[22:23], v9, s[12:15], s85 offen offset:96 sc1
    buffer_load_dwordx2 v[24:25], v9, s[12:15], s85 offen offset:128 sc1
    buffer_load_dwordx2 v[26:27], v9, s[12:15], s85 offen offset:160 sc1
    buffer_load_dwordx2 v[28:29], v9, s[12:15], s85 offen offset:192 sc1
    buffer_load_dwordx2 v[30:31], v9, s[12:15], s85 offen offset:224 sc1
    s_mov_b32 s75, s86
    buffer_load_dwordx4 v[32:35], v10, s[12:15], s75 offen sc1
    s_add_u32 s75, s75, 4096
    buffer_load_dwordx4 v[36:39], v10, s[12:15], s75 offen sc1
    s_add_u32 s75, s75, 4096
    buffer_load_dwordx4 v[40:43], v10, s[12:15], s75 offen sc1
    s_add_u32 s75, s75, 4096
    buffer_load_dwordx4 v[44:47], v10, s[12:15], s75 offen sc1
    s_add_u32 s75, s75, 4096
    buffer_load_dwordx4 v[48:51], v10, s[12:15], s75 offen sc1
    s_add_u32 s75, s75, 4096
    buffer_load_dwordx4 v[52:55], v10, s[12:15], s75 offen sc1
    s_add_u32 s75, s75, 4096
    buffer_load_dwordx4 v[56:59], v10, s[12:15], s75 offen sc1
    s_add_u32 s75, s75, 4096
    buffer_load_dwordx4 v[60:63], v10, s[12:15], s75 offen sc1
    s_branch L_wopoll
L_wogo:
    v_max_f32 v11, v16, v18
    v_max3_f32 v11, v11, v20, v22
    v_max3_f32 v11, v11, v24, v26
    v_max3_f32 v11, v11, v28, v30
    v_mov_b32 v12, v11
    s_nop 1
    v_permlane16_swap_b32 v11, v12
    v_max_f32 v11, v11, v12
    v_mov_b32 v12, v11
    s_nop 1
    v_permlane32_swap_b32 v11, v12
    v_max_f32 v11, v11, v12
    v_sub_f32 v16, v16, v11
    v_sub_f32 v18, v18, v11
    v_sub_f32 v20, v20, v11
    v_sub_f32 v22, v22, v11
    v_sub_f32 v24, v24, v11
    v_sub_f32 v26, v26, v11
    v_sub_f32 v28, v28, v11
    v_sub_f32 v30, v30, v11
    v_exp_f32 v16, v16
    v_exp_f32 v18, v18
    v_exp_f32 v20, v20
    v_exp_f32 v22, v22
    v_exp_f32 v24, v24
    v_exp_f32 v26, v26
    v_exp_f32 v28, v28
    v_exp_f32 v30, v30
    v_mul_f32 v11, v16, v17
    v_fmac_f32 v11, v18, v19
    v_fmac_f32 v11, v20, v21
    v_fmac_f32 v11, v22, v23
    v_fmac_f32 v11, v24, v25
    v_fmac_f32 v11, v26, v27
    v_fmac_f32 v11, v28, v29
    v_fmac_f32 v11, v30, v31
    v_mov_b32 v12, v11
    s_nop 1
    v_permlane16_swap_b32 v11, v12
    v_add_f32 v11, v11, v12
    v_mov_b32 v12, v11
    s_nop 1
    v_permlane32_swap_b32 v11, v12
    v_add_f32 v11, v11, v12
    v_rcp_f32 v12, v11
    v_mul_f32 v96, v32, v16
    v_mul_f32 v97, v33, v16
    v_mul_f32 v98, v34, v16
    v_mul_f32 v99, v35, v16
    v_fmac_f32 v96, v36, v18
    v_fmac_f32 v97, v37, v18
    v_fmac_f32 v98, v38, v18
    v_fmac_f32 v99, v39, v18
    v_fmac_f32 v96, v40, v20
    v_fmac_f32 v97, v41, v20
    v_fmac_f32 v98, v42, v20
    v_fmac_f32 v99, v43, v20
    v_fmac_f32 v96, v44, v22
    v_fmac_f32 v97, v45, v22
    v_fmac_f32 v98, v46, v22
    v_fmac_f32 v99, v47, v22
    v_fmac_f32 v96, v48, v24
    v_fmac_f32 v97, v49, v24
    v_fmac_f32 v98, v50, v24
    v_fmac_f32 v99, v51, v24
    v_fmac_f32 v96, v52, v26
    v_fmac_f32 v97, v53, v26
    v_fmac_f32 v98, v54, v26
    v_fmac_f32 v99, v55, v26
    v_fmac_f32 v96, v56, v28
    v_fmac_f32 v97, v57, v28
    v_fmac_f32 v98, v58, v28
    v_fmac_f32 v99, v59, v28
    v_fmac_f32 v96, v60, v30
    v_fmac_f32 v97, v61, v30
    v_fmac_f32 v98, v62, v30
    v_fmac_f32 v99, v63, v30
    v_mov_b32 v100, v96
    s_nop 1
    v_permlane16_swap_b32 v96, v100
    v_add_f32 v96, v96, v100
    v_mov_b32 v100, v96
    s_nop 1
    v_permlane32_swap_b32 v96, v100
    v_add_f32 v96, v96, v100
    v_mov_b32 v101, v97
    s_nop 1
    v_permlane16_swap_b32 v97, v101
    v_add_f32 v97, v97, v101
    v_mov_b32 v101, v97
    s_nop 1
    v_permlane32_swap_b32 v97, v101
    v_add_f32 v97, v97, v101
    v_mov_b32 v102, v98
    s_nop 1
    v_permlane16_swap_b32 v98, v102
    v_add_f32 v98, v98, v102
    v_mov_b32 v102, v98
    s_nop 1
    v_permlane32_swap_b32 v98, v102
    v_add_f32 v98, v98, v102
    v_mov_b32 v103, v99
    s_nop 1
    v_permlane16_swap_b32 v99, v103
    v_add_f32 v99, v99, v103
    v_mov_b32 v103, v99
    s_nop 1
    v_permlane32_swap_b32 v99, v103
    v_add_f32 v99, v99, v103
    v_mul_f32 v104, v96, v12
    v_fma_f32 v100, -v104, v11, v96
    v_fma_f32 v104, v100, v12, v104
    v_cvt_pk_bf16_f32 v104, v104, v104
    v_and_b32 v104, 0xffff0000, v104
    v_mul_f32 v105, v97, v12
    v_fma_f32 v101, -v105, v11, v97
    v_fma_f32 v105, v101, v12, v105
    v_cvt_pk_bf16_f32 v105, v105, v105
    v_and_b32 v105, 0xffff0000, v105
    v_mul_f32 v106, v98, v12
    v_fma_f32 v102, -v106, v11, v98
    v_fma_f32 v106, v102, v12, v106
    v_cvt_pk_bf16_f32 v106, v106, v106
    v_and_b32 v106, 0xffff0000, v106
    v_mul_f32 v107, v99, v12
    v_fma_f32 v103, -v107, v11, v99
    v_fma_f32 v107, v103, v12, v107
    v_cvt_pk_bf16_f32 v107, v107, v107
    v_and_b32 v107, 0xffff0000, v107
    v_and_b32 v13, 15, v1
    v_lshlrev_b32 v13, 4, v13
    s_lshl_b32 s75, s74, 8
    v_add_u32 v13, s75, v13
    ds_write_b128 v13, v[104:107] offset:14400
    v_lshrrev_b32 v13, 3, v1
    v_lshlrev_b32 v13, 2, v13
    v_add_u32 v13, s75, v13
    s_waitcnt lgkmcnt(0)
    ds_read_b32 v32, v13 offset:14400
    ds_read_b32 v34, v13 offset:14432
    ds_read_b32 v36, v13 offset:14464
    ds_read_b32 v38, v13 offset:14496
    ds_read_b32 v40, v13 offset:14528
    ds_read_b32 v42, v13 offset:14560
    ds_read_b32 v44, v13 offset:14592
    ds_read_b32 v46, v13 offset:14624
    v_mov_b32 v16, 0
    v_mov_b32 v17, 0
    v_mov_b32 v18, 0
    v_mov_b32 v19, 0
    v_mov_b32 v20, 0
    v_mov_b32 v21, 0
    v_mov_b32 v22, 0
    v_mov_b32 v23, 0
    v_lshlrev_b32 v96, 16, v64
    v_and_b32 v97, 0xffff0000, v64
    v_lshlrev_b32 v98, 16, v65
    v_and_b32 v99, 0xffff0000, v65
    v_lshlrev_b32 v100, 16, v66
    v_and_b32 v101, 0xffff0000, v66
    v_lshlrev_b32 v102, 16, v67
    v_and_b32 v103, 0xffff0000, v67
    s_waitcnt lgkmcnt(7)
    v_pk_fma_f32 v[16:17], v[96:97], v[32:33], v[16:17] op_sel_hi:[1,0,1]
    v_pk_fma_f32 v[18:19], v[98:99], v[32:33], v[18:19] op_sel_hi:[1,0,1]
    v_pk_fma_f32 v[20:21], v[100:101], v[32:33], v[20:21] op_sel_hi:[1,0,1]
    v_pk_fma_f32 v[22:23], v[102:103], v[32:33], v[22:23] op_sel_hi:[1,0,1]
    v_lshlrev_b32 v96, 16, v68
    v_and_b32 v97, 0xffff0000, v68
    v_lshlrev_b32 v98, 16, v69
    v_and_b32 v99, 0xffff0000, v69
    v_lshlrev_b32 v100, 16, v70
    v_and_b32 v101, 0xffff0000, v70
    v_lshlrev_b32 v102, 16, v71
    v_and_b32 v103, 0xffff0000, v71
    s_waitcnt lgkmcnt(6)
    v_pk_fma_f32 v[16:17], v[96:97], v[34:35], v[16:17] op_sel_hi:[1,0,1]
    v_pk_fma_f32 v[18:19], v[98:99], v[34:35], v[18:19] op_sel_hi:[1,0,1]
    v_pk_fma_f32 v[20:21], v[100:101], v[34:35], v[20:21] op_sel_hi:[1,0,1]
    v_pk_fma_f32 v[22:23], v[102:103], v[34:35], v[22:23] op_sel_hi:[1,0,1]
    v_lshlrev_b32 v96, 16, v72
    v_and_b32 v97, 0xffff0000, v72
    v_lshlrev_b32 v98, 16, v73
    v_and_b32 v99, 0xffff0000, v73
    v_lshlrev_b32 v100, 16, v74
    v_and_b32 v101, 0xffff0000, v74
    v_lshlrev_b32 v102, 16, v75
    v_and_b32 v103, 0xffff0000, v75
    s_waitcnt lgkmcnt(5)
    v_pk_fma_f32 v[16:17], v[96:97], v[36:37], v[16:17] op_sel_hi:[1,0,1]
    v_pk_fma_f32 v[18:19], v[98:99], v[36:37], v[18:19] op_sel_hi:[1,0,1]
    v_pk_fma_f32 v[20:21], v[100:101], v[36:37], v[20:21] op_sel_hi:[1,0,1]
    v_pk_fma_f32 v[22:23], v[102:103], v[36:37], v[22:23] op_sel_hi:[1,0,1]
    v_lshlrev_b32 v96, 16, v76
    v_and_b32 v97, 0xffff0000, v76
    v_lshlrev_b32 v98, 16, v77
    v_and_b32 v99, 0xffff0000, v77
    v_lshlrev_b32 v100, 16, v78
    v_and_b32 v101, 0xffff0000, v78
    v_lshlrev_b32 v102, 16, v79
    v_and_b32 v103, 0xffff0000, v79
    s_waitcnt lgkmcnt(4)
    v_pk_fma_f32 v[16:17], v[96:97], v[38:39], v[16:17] op_sel_hi:[1,0,1]
    v_pk_fma_f32 v[18:19], v[98:99], v[38:39], v[18:19] op_sel_hi:[1,0,1]
    v_pk_fma_f32 v[20:21], v[100:101], v[38:39], v[20:21] op_sel_hi:[1,0,1]
    v_pk_fma_f32 v[22:23], v[102:103], v[38:39], v[22:23] op_sel_hi:[1,0,1]
    v_lshlrev_b32 v96, 16, v80
    v_and_b32 v97, 0xffff0000, v80
    v_lshlrev_b32 v98, 16, v81
    v_and_b32 v99, 0xffff0000, v81
    v_lshlrev_b32 v100, 16, v82
    v_and_b32 v101, 0xffff0000, v82
    v_lshlrev_b32 v102, 16, v83
    v_and_b32 v103, 0xffff0000, v83
    s_waitcnt lgkmcnt(3)
    v_pk_fma_f32 v[16:17], v[96:97], v[40:41], v[16:17] op_sel_hi:[1,0,1]
    v_pk_fma_f32 v[18:19], v[98:99], v[40:41], v[18:19] op_sel_hi:[1,0,1]
    v_pk_fma_f32 v[20:21], v[100:101], v[40:41], v[20:21] op_sel_hi:[1,0,1]
    v_pk_fma_f32 v[22:23], v[102:103], v[40:41], v[22:23] op_sel_hi:[1,0,1]
    v_lshlrev_b32 v96, 16, v84
    v_and_b32 v97, 0xffff0000, v84
    v_lshlrev_b32 v98, 16, v85
    v_and_b32 v99, 0xffff0000, v85
    v_lshlrev_b32 v100, 16, v86
    v_and_b32 v101, 0xffff0000, v86
    v_lshlrev_b32 v102, 16, v87
    v_and_b32 v103, 0xffff0000, v87
    s_waitcnt lgkmcnt(2)
    v_pk_fma_f32 v[16:17], v[96:97], v[42:43], v[16:17] op_sel_hi:[1,0,1]
    v_pk_fma_f32 v[18:19], v[98:99], v[42:43], v[18:19] op_sel_hi:[1,0,1]
    v_pk_fma_f32 v[20:21], v[100:101], v[42:43], v[20:21] op_sel_hi:[1,0,1]
    v_pk_fma_f32 v[22:23], v[102:103], v[42:43], v[22:23] op_sel_hi:[1,0,1]
    v_lshlrev_b32 v96, 16, v88
    v_and_b32 v97, 0xffff0000, v88
    v_lshlrev_b32 v98, 16, v89
    v_and_b32 v99, 0xffff0000, v89
    v_lshlrev_b32 v100, 16, v90
    v_and_b32 v101, 0xffff0000, v90
    v_lshlrev_b32 v102, 16, v91
    v_and_b32 v103, 0xffff0000, v91
    s_waitcnt lgkmcnt(1)
    v_pk_fma_f32 v[16:17], v[96:97], v[44:45], v[16:17] op_sel_hi:[1,0,1]
    v_pk_fma_f32 v[18:19], v[98:99], v[44:45], v[18:19] op_sel_hi:[1,0,1]
    v_pk_fma_f32 v[20:21], v[100:101], v[44:45], v[20:21] op_sel_hi:[1,0,1]
    v_pk_fma_f32 v[22:23], v[102:103], v[44:45], v[22:23] op_sel_hi:[1,0,1]
    v_lshlrev_b32 v96, 16, v92
    v_and_b32 v97, 0xffff0000, v92
    v_lshlrev_b32 v98, 16, v93
    v_and_b32 v99, 0xffff0000, v93
    v_lshlrev_b32 v100, 16, v94
    v_and_b32 v101, 0xffff0000, v94
    v_lshlrev_b32 v102, 16, v95
    v_and_b32 v103, 0xffff0000, v95
    s_waitcnt lgkmcnt(0)
    v_pk_fma_f32 v[16:17], v[96:97], v[46:47], v[16:17] op_sel_hi:[1,0,1]
    v_pk_fma_f32 v[18:19], v[98:99], v[46:47], v[18:19] op_sel_hi:[1,0,1]
    v_pk_fma_f32 v[20:21], v[100:101], v[46:47], v[20:21] op_sel_hi:[1,0,1]
    v_pk_fma_f32 v[22:23], v[102:103], v[46:47], v[22:23] op_sel_hi:[1,0,1]
    v_add_f32_dpp v16, v16, v16 row_ror:8 row_mask:0xf bank_mask:0xf
    v_add_f32_dpp v17, v17, v17 row_ror:8 row_mask:0xf bank_mask:0xf
    v_add_f32_dpp v18, v18, v18 row_ror:8 row_mask:0xf bank_mask:0xf
    v_add_f32_dpp v19, v19, v19 row_ror:8 row_mask:0xf bank_mask:0xf
    v_add_f32_dpp v20, v20, v20 row_ror:8 row_mask:0xf bank_mask:0xf
    v_add_f32_dpp v21, v21, v21 row_ror:8 row_mask:0xf bank_mask:0xf
    v_add_f32_dpp v22, v22, v22 row_ror:8 row_mask:0xf bank_mask:0xf
    v_add_f32_dpp v23, v23, v23 row_ror:8 row_mask:0xf bank_mask:0xf
    v_and_b32 v13, 7, v1
    v_lshlrev_b32 v13, 5, v13
    v_lshl_add_u32 v13, v7, 8, v13
    s_lshl_b32 s75, s74, 10
    v_add_u32 v13, s75, v13
    ds_write_b128 v13, v[16:19] offset:15424
    ds_write_b128 v13, v[20:23] offset:15440
    s_waitcnt lgkmcnt(0)
    s_barrier
    s_cmp_lg_u32 s74, 0
    s_cbranch_scc1 L_end
    v_lshlrev_b32 v13, 2, v1
    ds_read_b32 v16, v13 offset:15424
    ds_read_b32 v17, v13 offset:15680
    ds_read_b32 v18, v13 offset:15936
    ds_read_b32 v19, v13 offset:16192
    ds_read_b32 v20, v13 offset:16448
    ds_read_b32 v21, v13 offset:16704
    ds_read_b32 v22, v13 offset:16960
    ds_read_b32 v23, v13 offset:17216
    ds_read_b32 v24, v13 offset:17472
    ds_read_b32 v25, v13 offset:17728
    ds_read_b32 v26, v13 offset:17984
    ds_read_b32 v27, v13 offset:18240
    ds_read_b32 v28, v13 offset:18496
    ds_read_b32 v29, v13 offset:18752
    ds_read_b32 v30, v13 offset:19008
    ds_read_b32 v31, v13 offset:19264
    s_waitcnt lgkmcnt(0)
    v_add_f32 v16, v16, v24
    v_add_f32 v17, v17, v25
    v_add_f32 v18, v18, v26
    v_add_f32 v19, v19, v27
    v_add_f32 v20, v20, v28
    v_add_f32 v21, v21, v29
    v_add_f32 v22, v22, v30
    v_add_f32 v23, v23, v31
    v_add_f32 v16, v16, v20
    v_add_f32 v17, v17, v21
    v_add_f32 v18, v18, v22
    v_add_f32 v19, v19, v23
    v_add_f32 v16, v16, v18
    v_add_f32 v17, v17, v19
    v_add_f32 v16, v16, v17
    v_min_u32 v16, 0xfffffffe, v16
    s_mul_i32 s76, s81, 1792
    s_lshl_b32 s77, s82, 8
    s_add_u32 s76, s76, s77
    s_add_u32 s76, s76, 540672
    buffer_store_dword v16, v13, s[12:15], s76 offen sc1
    s_branch L_end
L_ffn:
    v_and_b32 v11, 31, v1
    v_cmp_gt_u32 vcc, 28, v11
    v_lshlrev_b32 v12, 3, v11
    s_nop 0
    v_cndmask_b32 v12, v8, v12, vcc
    s_mul_i32 s75, s74, 224
    buffer_load_dwordx2 v[4:5], v12, s[20:23], s75 offen
    v_lshlrev_b32 v14, 4, v11
    v_lshrrev_b32 v12, 5, v1
    v_mul_u32_u24 v12, 1792, v12
    v_add_u32 v14, v14, v12
    v_cndmask_b32 v14, v8, v14, vcc
    v_and_b32 v9, 15, v1
    v_lshrrev_b32 v10, 2, v9
    v_and_b32 v9, 3, v9
    v_lshl_add_u32 v12, v7, 2, v10
    v_mul_u32_u24 v12, 896, v12
    v_lshl_add_u32 v12, v9, 3, v12
    s_mul_i32 s75, s74, 224
    s_add_u32 s75, s75, 61440
    v_add_u32 v12, s75, v12
    ds_read_b64_tr_b16 v[48:49], v12 offset:0
    ds_read_b64_tr_b16 v[50:51], v12 offset:32
    ds_read_b64_tr_b16 v[52:53], v12 offset:64
    ds_read_b64_tr_b16 v[54:55], v12 offset:96
    ds_read_b64_tr_b16 v[56:57], v12 offset:128
    ds_read_b64_tr_b16 v[58:59], v12 offset:160
    ds_read_b64_tr_b16 v[60:61], v12 offset:192
    s_cmp_ge_u32 s74, 2
    s_cbranch_scc1 L_ffnogu
    v_lshl_add_u32 v12, v7, 3, v10
    v_lshlrev_b32 v12, 5, v12
    v_lshl_add_u32 v12, v9, 3, v12
    s_mul_i32 s75, s74, 14336
    s_add_u32 s75, s75, 32768
    v_add_u32 v12, s75, v12
    ds_read_b64_tr_b16 v[64:65], v12 offset:0
    ds_read_b64_tr_b16 v[66:67], v12 offset:128
    ds_read_b64_tr_b16 v[68:69], v12 offset:1024
    ds_read_b64_tr_b16 v[70:71], v12 offset:1152
    ds_read_b64_tr_b16 v[72:73], v12 offset:2048
    ds_read_b64_tr_b16 v[74:75], v12 offset:2176
    ds_read_b64_tr_b16 v[76:77], v12 offset:3072
    ds_read_b64_tr_b16 v[78:79], v12 offset:3200
    ds_read_b64_tr_b16 v[80:81], v12 offset:4096
    ds_read_b64_tr_b16 v[82:83], v12 offset:4224
    ds_read_b64_tr_b16 v[84:85], v12 offset:5120
    ds_read_b64_tr_b16 v[86:87], v12 offset:5248
    ds_read_b64_tr_b16 v[88:89], v12 offset:6144
    ds_read_b64_tr_b16 v[90:91], v12 offset:6272
    ds_read_b64_tr_b16 v[92:93], v12 offset:7168
    ds_read_b64_tr_b16 v[94:95], v12 offset:7296
    ds_read_b64_tr_b16 v[96:97], v12 offset:8192
    ds_read_b64_tr_b16 v[98:99], v12 offset:8320
    ds_read_b64_tr_b16 v[100:101], v12 offset:9216
    ds_read_b64_tr_b16 v[102:103], v12 offset:9344
    ds_read_b64_tr_b16 v[104:105], v12 offset:10240
    ds_read_b64_tr_b16 v[106:107], v12 offset:10368
    ds_read_b64_tr_b16 v[108:109], v12 offset:11264
    ds_read_b64_tr_b16 v[110:111], v12 offset:11392
    ds_read_b64_tr_b16 v[112:113], v12 offset:12288
    ds_read_b64_tr_b16 v[114:115], v12 offset:12416
    ds_read_b64_tr_b16 v[116:117], v12 offset:13312
    ds_read_b64_tr_b16 v[118:119], v12 offset:13440
L_ffnogu:
    s_mul_i32 s85, s74, 448
    s_add_u32 s85, s85, 540672
    s_add_u32 s76, s85, 25088
L_ffpre:
    buffer_load_dwordx4 v[16:19], v14, s[12:15], s76 offen sc1
    s_waitcnt vmcnt(0)
    v_max_u32 v9, v16, v17
    v_max3_u32 v9, v9, v18, v19
    v_cmp_eq_u32 vcc, -1, v9
    s_nop 1
    s_cbranch_vccnz L_ffpre2
    s_branch L_ffpoll
L_ffpre2:
    s_add_u32 s89, s89, 1
    s_cmp_gt_u32 s89, 100000
    s_cbranch_scc1 L_ffpoll
    s_sleep 8
    s_branch L_ffpre
L_ffpoll:
    s_mov_b32 s75, s85
    buffer_load_dwordx4 v[16:19], v14, s[12:15], s75 offen sc1
    s_add_u32 s75, s75, 3584
    buffer_load_dwordx4 v[20:23], v14, s[12:15], s75 offen sc1
    s_add_u32 s75, s75, 3584
    buffer_load_dwordx4 v[24:27], v14, s[12:15], s75 offen sc1
    s_add_u32 s75, s75, 3584
    buffer_load_dwordx4 v[28:31], v14, s[12:15], s75 offen sc1
    s_add_u32 s75, s75, 3584
    buffer_load_dwordx4 v[32:35], v14, s[12:15], s75 offen sc1
    s_add_u32 s75, s75, 3584
    buffer_load_dwordx4 v[36:39], v14, s[12:15], s75 offen sc1
    s_add_u32 s75, s75, 3584
    buffer_load_dwordx4 v[40:43], v14, s[12:15], s75 offen sc1
    s_add_u32 s75, s75, 3584
    buffer_load_dwordx4 v[44:47], v14, s[12:15], s75 offen sc1
    s_waitcnt vmcnt(0)
    v_max_u32 v9, v16, v17
    v_max3_u32 v9, v9, v18, v19
    v_max3_u32 v9, v9, v20, v21
    v_max3_u32 v9, v9, v22, v23
    v_max3_u32 v9, v9, v24, v25
    v_max3_u32 v9, v9, v26, v27
    v_max3_u32 v9, v9, v28, v29
    v_max3_u32 v9, v9, v30, v31
    v_max3_u32 v9, v9, v32, v33
    v_max3_u32 v9, v9, v34, v35
    v_max3_u32 v9, v9, v36, v37
    v_max3_u32 v9, v9, v38, v39
    v_max3_u32 v9, v9, v40, v41
    v_max3_u32 v9, v9, v42, v43
    v_max3_u32 v9, v9, v44, v45
    v_max3_u32 v9, v9, v46, v47
    v_cmp_eq_u32 vcc, -1, v9
    s_nop 1
    s_cbranch_vccnz L_ffre
    s_branch L_ffgo
L_ffre:
    s_add_u32 s89, s89, 1
    s_cmp_gt_u32 s89, 100000
    s_cbranch_scc1 L_ffgo
    s_sleep 1
    s_branch L_ffpoll
L_ffgo:
    v_add_f32 v16, v16, v32
    v_add_f32 v17, v17, v33
    v_add_f32 v18, v18, v34
    v_add_f32 v19, v19, v35
    v_add_f32 v20, v20, v36
    v_add_f32 v21, v21, v37
    v_add_f32 v22, v22, v38
    v_add_f32 v23, v23, v39
    v_add_f32 v24, v24, v40
    v_add_f32 v25, v25, v41
    v_add_f32 v26, v26, v42
    v_add_f32 v27, v27, v43
    v_add_f32 v28, v28, v44
    v_add_f32 v29, v29, v45
    v_add_f32 v30, v30, v46
    v_add_f32 v31, v31, v47
    v_add_f32 v16, v16, v24
    v_add_f32 v17, v17, v25
    v_add_f32 v18, v18, v26
    v_add_f32 v19, v19, v27
    v_add_f32 v20, v20, v28
    v_add_f32 v21, v21, v29
    v_add_f32 v22, v22, v30
    v_add_f32 v23, v23, v31
    v_add_f32 v16, v16, v20
    v_add_f32 v17, v17, v21
    v_add_f32 v18, v18, v22
    v_add_f32 v19, v19, v23
    v_lshlrev_b32 v24, 16, v4
    v_and_b32 v25, 0xffff0000, v4
    v_lshlrev_b32 v26, 16, v5
    v_and_b32 v27, 0xffff0000, v5
    v_mov_b32 v20, v16
    s_nop 1
    v_permlane32_swap_b32 v16, v20
    v_add_f32 v16, v16, v20
    v_mov_b32 v21, v17
    s_nop 1
    v_permlane32_swap_b32 v17, v21
    v_add_f32 v17, v17, v21
    v_mov_b32 v22, v18
    s_nop 1
    v_permlane32_swap_b32 v18, v22
    v_add_f32 v18, v18, v22
    v_mov_b32 v23, v19
    s_nop 1
    v_permlane32_swap_b32 v19, v23
    v_add_f32 v19, v19, v23
    v_cvt_pk_bf16_f32 v16, v16, v16
    v_and_b32 v16, 0xffff0000, v16
    v_add_f32 v16, v16, v24
    v_cvt_pk_bf16_f32 v16, v16, v16
    v_and_b32 v16, 0xffff0000, v16
    v_cvt_pk_bf16_f32 v17, v17, v17
    v_and_b32 v17, 0xffff0000, v17
    v_add_f32 v17, v17, v25
    v_cvt_pk_bf16_f32 v17, v17, v17
    v_and_b32 v17, 0xffff0000, v17
    v_cvt_pk_bf16_f32 v18, v18, v18
    v_and_b32 v18, 0xffff0000, v18
    v_add_f32 v18, v18, v26
    v_cvt_pk_bf16_f32 v18, v18, v18
    v_and_b32 v18, 0xffff0000, v18
    v_cvt_pk_bf16_f32 v19, v19, v19
    v_and_b32 v19, 0xffff0000, v19
    v_add_f32 v19, v19, v27
    v_cvt_pk_bf16_f32 v19, v19, v19
    v_and_b32 v19, 0xffff0000, v19
    v_add_f32 v9, v16, v17
    v_add_f32 v10, v18, v19
    v_add_f32 v9, v9, v10
    s_nop 1
    v_add_f32_dpp v9, v9, v9 quad_perm:[1,0,3,2] row_mask:0xf bank_mask:0xf
    s_nop 1
    v_add_f32_dpp v9, v9, v9 quad_perm:[2,3,0,1] row_mask:0xf bank_mask:0xf
    s_nop 1
    v_add_f32_dpp v9, v9, v9 row_half_mirror row_mask:0xf bank_mask:0xf
    s_nop 1
    v_add_f32_dpp v9, v9, v9 row_mirror row_mask:0xf bank_mask:0xf
    v_mov_b32 v10, v9
    s_nop 1
    v_permlane16_swap_b32 v9, v10
    v_add_f32 v9, v9, v10
    v_mov_b32 v10, v9
    s_nop 1
    v_permlane32_swap_b32 v9, v10
    v_add_f32 v9, v9, v10
    v_mul_f32 v9, 0x3b924925, v9
    v_mov_b32 v11, 0
    v_sub_f32 v10, v16, v9
    v_fmac_f32 v11, v10, v10
    v_sub_f32 v10, v17, v9
    v_fmac_f32 v11, v10, v10
    v_sub_f32 v10, v18, v9
    v_fmac_f32 v11, v10, v10
    v_sub_f32 v10, v19, v9
    v_fmac_f32 v11, v10, v10
    v_and_b32 v12, 31, v1
    v_cmp_gt_u32 vcc, 28, v12
    s_nop 1
    v_cndmask_b32 v11, 0, v11, vcc
    s_nop 1
    v_add_f32_dpp v11, v11, v11 quad_perm:[1,0,3,2] row_mask:0xf bank_mask:0xf
    s_nop 1
    v_add_f32_dpp v11, v11, v11 quad_perm:[2,3,0,1] row_mask:0xf bank_mask:0xf
    s_nop 1
    v_add_f32_dpp v11, v11, v11 row_half_mirror row_mask:0xf bank_mask:0xf
    s_nop 1
    v_add_f32_dpp v11, v11, v11 row_mirror row_mask:0xf bank_mask:0xf
    v_mov_b32 v10, v11
    s_nop 1
    v_permlane16_swap_b32 v11, v10
    v_add_f32 v11, v11, v10
    v_mov_b32 v10, v11
    s_nop 1
    v_permlane32_swap_b32 v11, v10
    v_add_f32 v11, v11, v10
    v_mul_f32 v11, 0.5, v11
    v_mov_b32 v10, v9
    s_lshl_b32 s75, s74, 3
    v_mov_b32 v12, s75
    ds_write_b64 v12, v[10:11] offset:19520
    s_waitcnt lgkmcnt(0)
    s_barrier
    v_mov_b32 v12, 0
    ds_read_b128 v[20:23], v12 offset:19520
    ds_read_b128 v[24:27], v12 offset:19536
    s_waitcnt lgkmcnt(0)
    v_add_f32 v9, v20, v22
    v_add_f32 v10, v24, v26
    v_add_f32 v9, v9, v10
    v_mul_f32 v9, 0.25, v9
    v_add_f32 v11, v21, v23
    v_add_f32 v10, v25, v27
    v_add_f32 v11, v11, v10
    v_mov_b32 v13, 0
    v_sub_f32 v10, v20, v9
    v_fmac_f32 v13, v10, v10
    v_sub_f32 v10, v22, v9
    v_fmac_f32 v13, v10, v10
    v_sub_f32 v10, v24, v9
    v_fmac_f32 v13, v10, v10
    v_sub_f32 v10, v26, v9
    v_fmac_f32 v13, v10, v10
    v_mov_b32 v10, 0x42e00000
    v_fmac_f32 v11, v13, v10
    v_mul_f32 v11, 0x3b124925, v11
    v_cvt_pk_bf16_f32 v9, v9, v9
    v_and_b32 v9, 0xffff0000, v9
    v_cvt_pk_bf16_f32 v11, v11, v11
    v_and_b32 v11, 0xffff0000, v11
    v_add_f32 v11, 0x3727c5ac, v11
    v_cvt_pk_bf16_f32 v11, v11, v11
    v_and_b32 v11, 0xffff0000, v11
    v_sqrt_f32 v11, v11
    s_nop 0
    v_cvt_pk_bf16_f32 v11, v11, v11
    v_and_b32 v11, 0xffff0000, v11
    v_rcp_f32 v10, v11
    v_sub_f32 v20, v16, v9
    v_cvt_pk_bf16_f32 v20, v20, v20
    v_and_b32 v20, 0xffff0000, v20
    v_mul_f32 v24, v20, v10
    v_fma_f32 v12, -v24, v11, v20
    v_fma_f32 v24, v12, v10, v24
    v_sub_f32 v21, v17, v9
    v_cvt_pk_bf16_f32 v21, v21, v21
    v_and_b32 v21, 0xffff0000, v21
    v_mul_f32 v25, v21, v10
    v_fma_f32 v12, -v25, v11, v21
    v_fma_f32 v25, v12, v10, v25
    v_sub_f32 v22, v18, v9
    v_cvt_pk_bf16_f32 v22, v22, v22
    v_and_b32 v22, 0xffff0000, v22
    v_mul_f32 v26, v22, v10
    v_fma_f32 v12, -v26, v11, v22
    v_fma_f32 v26, v12, v10, v26
    v_sub_f32 v23, v19, v9
    v_cvt_pk_bf16_f32 v23, v23, v23
    v_and_b32 v23, 0xffff0000, v23
    v_mul_f32 v27, v23, v10
    v_fma_f32 v12, -v27, v11, v23
    v_fma_f32 v27, v12, v10, v27
    v_cvt_pk_bf16_f32 v24, v24, v25
    v_cvt_pk_bf16_f32 v25, v26, v27
    v_and_b32 v12, 31, v1
    v_cmp_gt_u32 vcc, 28, v12
    v_lshlrev_b32 v12, 3, v12
    s_mul_i32 s75, s74, 224
    v_add_u32 v12, s75, v12
    s_and_saveexec_b64 s[98:99], vcc
    ds_write_b64 v12, v[24:25] offset:19584
    s_mov_b64 exec, s[98:99]
    v_mov_b32 v16, 0
    v_mov_b32 v17, 0
    v_mov_b32 v18, 0
    v_mov_b32 v19, 0
    v_mov_b32 v20, 0
    v_mov_b32 v21, 0
    v_mov_b32 v22, 0
    v_mov_b32 v23, 0
    v_mov_b32 v24, 0
    v_mov_b32 v25, 0
    v_mov_b32 v26, 0
    v_mov_b32 v27, 0
    v_mov_b32 v28, 0
    v_mov_b32 v29, 0
    v_mov_b32 v30, 0
    v_mov_b32 v31, 0
    v_mov_b32 v32, 0
    v_mov_b32 v33, 0
    v_mov_b32 v34, 0
    v_mov_b32 v35, 0
    v_mov_b32 v36, 0
    v_mov_b32 v37, 0
    v_mov_b32 v38, 0
    v_mov_b32 v39, 0
    v_mov_b32 v40, 0
    v_mov_b32 v41, 0
    v_mov_b32 v42, 0
    v_mov_b32 v43, 0
    v_and_b32 v9, 15, v1
    v_cmp_eq_u32 vcc, 0, v9
    v_lshlrev_b32 v12, 4, v7
    s_waitcnt lgkmcnt(0)
    s_barrier
    s_cmp_ge_u32 s74, 2
    s_cbranch_scc1 L_ffnomm
    s_and_saveexec_b64 s[98:99], vcc
    ds_read_b128 v[16:19], v12 offset:19584
    ds_read_b128 v[20:23], v12 offset:19648
    ds_read_b128 v[24:27], v12 offset:19712
    ds_read_b128 v[28:31], v12 offset:19776
    ds_read_b128 v[32:35], v12 offset:19840
    ds_read_b128 v[36:39], v12 offset:19904
    ds_read_b128 v[40:43], v12 offset:19968
    s_mov_b64 exec, s[98:99]
    s_waitcnt lgkmcnt(6)
    v_mfma_f32_16x16x32_bf16 v[44:47], v[64:67], v[16:19], 0
    s_waitcnt lgkmcnt(5)
    v_mfma_f32_16x16x32_bf16 v[44:47], v[68:71], v[20:23], v[44:47]
    s_waitcnt lgkmcnt(4)
    v_mfma_f32_16x16x32_bf16 v[44:47], v[72:75], v[24:27], v[44:47]
    s_waitcnt lgkmcnt(3)
    v_mfma_f32_16x16x32_bf16 v[44:47], v[76:79], v[28:31], v[44:47]
    s_waitcnt lgkmcnt(2)
    v_mfma_f32_16x16x32_bf16 v[44:47], v[80:83], v[32:35], v[44:47]
    s_waitcnt lgkmcnt(1)
    v_mfma_f32_16x16x32_bf16 v[44:47], v[84:87], v[36:39], v[44:47]
    s_waitcnt lgkmcnt(0)
    v_mfma_f32_16x16x32_bf16 v[44:47], v[88:91], v[40:43], v[44:47]
    s_and_saveexec_b64 s[98:99], vcc
    ds_read_b128 v[16:19], v12 offset:20032
    ds_read_b128 v[20:23], v12 offset:20096
    ds_read_b128 v[24:27], v12 offset:20160
    ds_read_b128 v[28:31], v12 offset:20224
    ds_read_b128 v[32:35], v12 offset:20288
    ds_read_b128 v[36:39], v12 offset:20352
    ds_read_b128 v[40:43], v12 offset:20416
    s_mov_b64 exec, s[98:99]
    s_waitcnt lgkmcnt(6)
    v_mfma_f32_16x16x32_bf16 v[44:47], v[92:95], v[16:19], v[44:47]
    s_waitcnt lgkmcnt(5)
    v_mfma_f32_16x16x32_bf16 v[44:47], v[96:99], v[20:23], v[44:47]
    s_waitcnt lgkmcnt(4)
    v_mfma_f32_16x16x32_bf16 v[44:47], v[100:103], v[24:27], v[44:47]
    s_waitcnt lgkmcnt(3)
    v_mfma_f32_16x16x32_bf16 v[44:47], v[104:107], v[28:31], v[44:47]
    s_waitcnt lgkmcnt(2)
    v_mfma_f32_16x16x32_bf16 v[44:47], v[108:111], v[32:35], v[44:47]
    s_waitcnt lgkmcnt(1)
    v_mfma_f32_16x16x32_bf16 v[44:47], v[112:115], v[36:39], v[44:47]
    s_waitcnt lgkmcnt(0)
    v_mfma_f32_16x16x32_bf16 v[44:47], v[116:119], v[40:43], v[44:47]
    s_nop 7
    v_cvt_pk_bf16_f32 v44, v44, v44
    v_and_b32 v44, 0xffff0000, v44
    v_cvt_pk_bf16_f32 v45, v45, v45
    v_and_b32 v45, 0xffff0000, v45
    v_cvt_pk_bf16_f32 v46, v46, v46
    v_and_b32 v46, 0xffff0000, v46
    v_cvt_pk_bf16_f32 v47, v47, v47
    v_and_b32 v47, 0xffff0000, v47
    s_lshl_b32 s75, s74, 6
    v_add_u32 v13, s75, v12
    s_and_saveexec_b64 s[98:99], vcc
    ds_write_b128 v13, v[44:47] offset:21376
    s_mov_b64 exec, s[98:99]
L_ffnomm:
    s_waitcnt lgkmcnt(0)
    s_barrier
    ds_read_b128 v[16:19], v12 offset:21376
    ds_read_b128 v[20:23], v12 offset:21440
    v_mov_b32 v28, 0x3d372713
    s_waitcnt lgkmcnt(0)
    v_mul_f32 v24, v16, v16
    v_mul_f32 v25, v17, v17
    v_mul_f32 v26, v18, v18
    v_mul_f32 v27, v19, v19
    v_fma_f32 v24, v24, v28, 1.0
    v_fma_f32 v25, v25, v28, 1.0
    v_fma_f32 v26, v26, v28, 1.0
    v_fma_f32 v27, v27, v28, 1.0
    v_mul_f32 v24, v24, v16
    v_mul_f32 v25, v25, v17
    v_mul_f32 v26, v26, v18
    v_mul_f32 v27, v27, v19
    v_mul_f32 v24, 0x40135761, v24
    v_mul_f32 v25, 0x40135761, v25
    v_mul_f32 v26, 0x40135761, v26
    v_mul_f32 v27, 0x40135761, v27
    v_exp_f32 v24, v24
    v_exp_f32 v25, v25
    v_exp_f32 v26, v26
    v_exp_f32 v27, v27
    v_add_f32 v24, 1.0, v24
    v_add_f32 v25, 1.0, v25
    v_add_f32 v26, 1.0, v26
    v_add_f32 v27, 1.0, v27
    v_rcp_f32 v24, v24
    v_rcp_f32 v25, v25
    v_rcp_f32 v26, v26
    v_rcp_f32 v27, v27
    v_fma_f32 v24, v24, -2.0, 2.0
    v_fma_f32 v25, v25, -2.0, 2.0
    v_fma_f32 v26, v26, -2.0, 2.0
    v_fma_f32 v27, v27, -2.0, 2.0
    v_mul_f32 v24, v24, v16
    v_mul_f32 v25, v25, v17
    v_mul_f32 v26, v26, v18
    v_mul_f32 v27, v27, v19
    v_mul_f32 v24, 0.5, v24
    v_mul_f32 v25, 0.5, v25
    v_mul_f32 v26, 0.5, v26
    v_mul_f32 v27, 0.5, v27
    v_cvt_pk_bf16_f32 v24, v24, v24
    v_and_b32 v24, 0xffff0000, v24
    v_cvt_pk_bf16_f32 v25, v25, v25
    v_and_b32 v25, 0xffff0000, v25
    v_cvt_pk_bf16_f32 v26, v26, v26
    v_and_b32 v26, 0xffff0000, v26
    v_cvt_pk_bf16_f32 v27, v27, v27
    v_and_b32 v27, 0xffff0000, v27
    v_mul_f32 v24, v24, v20
    v_mul_f32 v25, v25, v21
    v_mul_f32 v26, v26, v22
    v_mul_f32 v27, v27, v23
    v_cvt_pk_bf16_f32 v24, v24, v25
    v_cvt_pk_bf16_f32 v25, v26, v27
    v_cndmask_b32 v24, 0, v24, vcc
    v_cndmask_b32 v25, 0, v25, vcc
    s_nop 1
    v_mfma_f32_16x16x16_bf16 v[64:67], v[48:49], v[24:25], 0
    v_mfma_f32_16x16x16_bf16 v[68:71], v[50:51], v[24:25], 0
    v_mfma_f32_16x16x16_bf16 v[72:75], v[52:53], v[24:25], 0
    v_mfma_f32_16x16x16_bf16 v[76:79], v[54:55], v[24:25], 0
    v_mfma_f32_16x16x16_bf16 v[80:83], v[56:57], v[24:25], 0
    v_mfma_f32_16x16x16_bf16 v[84:87], v[58:59], v[24:25], 0
    v_mfma_f32_16x16x16_bf16 v[88:91], v[60:61], v[24:25], 0
    v_cndmask_b32 v13, v8, v12, vcc
    s_mul_i32 s76, s83, 1792
    s_mul_i32 s75, s74, 448
    s_add_u32 s76, s76, s75
    s_add_u32 s76, s76, 573440
    v_min_u32 v64, 0xfffffffe, v64
    v_min_u32 v65, 0xfffffffe, v65
    v_min_u32 v66, 0xfffffffe, v66
    v_min_u32 v67, 0xfffffffe, v67
    buffer_store_dwordx4 v[64:67], v13, s[12:15], s76 offen offset:0 sc1
    v_min_u32 v68, 0xfffffffe, v68
    v_min_u32 v69, 0xfffffffe, v69
    v_min_u32 v70, 0xfffffffe, v70
    v_min_u32 v71, 0xfffffffe, v71
    buffer_store_dwordx4 v[68:71], v13, s[12:15], s76 offen offset:64 sc1
    v_min_u32 v72, 0xfffffffe, v72
    v_min_u32 v73, 0xfffffffe, v73
    v_min_u32 v74, 0xfffffffe, v74
    v_min_u32 v75, 0xfffffffe, v75
    buffer_store_dwordx4 v[72:75], v13, s[12:15], s76 offen offset:128 sc1
    v_min_u32 v76, 0xfffffffe, v76
    v_min_u32 v77, 0xfffffffe, v77
    v_min_u32 v78, 0xfffffffe, v78
    v_min_u32 v79, 0xfffffffe, v79
    buffer_store_dwordx4 v[76:79], v13, s[12:15], s76 offen offset:192 sc1
    v_min_u32 v80, 0xfffffffe, v80
    v_min_u32 v81, 0xfffffffe, v81
    v_min_u32 v82, 0xfffffffe, v82
    v_min_u32 v83, 0xfffffffe, v83
    buffer_store_dwordx4 v[80:83], v13, s[12:15], s76 offen offset:256 sc1
    v_min_u32 v84, 0xfffffffe, v84
    v_min_u32 v85, 0xfffffffe, v85
    v_min_u32 v86, 0xfffffffe, v86
    v_min_u32 v87, 0xfffffffe, v87
    buffer_store_dwordx4 v[84:87], v13, s[12:15], s76 offen offset:320 sc1
    v_min_u32 v88, 0xfffffffe, v88
    v_min_u32 v89, 0xfffffffe, v89
    v_min_u32 v90, 0xfffffffe, v90
    v_min_u32 v91, 0xfffffffe, v91
    buffer_store_dwordx4 v[88:91], v13, s[12:15], s76 offen offset:384 sc1
    s_branch L_end
L_fin:
    s_cmp_lg_u32 s74, 0
    s_cbranch_scc1 L_end
    s_sub_u32 s82, s73, 14
    s_mul_i32 s82, s82, 7
    s_add_u32 s82, s82, s72
    v_and_b32 v11, 7, v1
    v_lshlrev_b32 v12, 3, v11
    s_lshl_b32 s75, s82, 6
    buffer_load_dwordx2 v[48:49], v12, s[20:23], s75 offen
    v_lshlrev_b32 v14, 4, v11
    v_lshrrev_b32 v10, 3, v1
    v_mul_u32_u24 v10, 1792, v10
    v_add_u32 v14, v14, v10
    s_lshl_b32 s85, s82, 7
    s_add_u32 s86, s85, 573440
    s_add_u32 s85, s85, 540672
    s_add_u32 s76, s85, 14336
L_f2poll:
    buffer_load_dwordx4 v[16:19], v14, s[12:15], s85 offen sc1
    buffer_load_dwordx4 v[20:23], v14, s[12:15], s76 offen sc1
    s_waitcnt vmcnt(0)
    v_max_u32 v9, v16, v17
    v_max3_u32 v9, v9, v18, v19
    v_max3_u32 v9, v9, v20, v21
    v_max3_u32 v9, v9, v22, v23
    v_cmp_eq_u32 vcc, -1, v9
    s_nop 1
    s_cbranch_vccnz L_f2re
    s_branch L_f2go
L_f2re:
    s_add_u32 s89, s89, 1
    s_cmp_gt_u32 s89, 100000
    s_cbranch_scc1 L_f2go
    s_sleep 8
    s_branch L_f2poll
L_f2go:
    v_lshlrev_b32 v50, 16, v48
    v_and_b32 v51, 0xffff0000, v48
    v_lshlrev_b32 v52, 16, v49
    v_and_b32 v53, 0xffff0000, v49
    v_add_f32 v16, v16, v20
    v_add_f32 v17, v17, v21
    v_add_f32 v18, v18, v22
    v_add_f32 v19, v19, v23
    v_add_f32_dpp v16, v16, v16 row_ror:8 row_mask:0xf bank_mask:0xf
    v_mov_b32 v20, v16
    s_nop 1
    v_permlane16_swap_b32 v16, v20
    v_add_f32 v16, v16, v20
    v_mov_b32 v20, v16
    s_nop 1
    v_permlane32_swap_b32 v16, v20
    v_add_f32 v16, v16, v20
    v_add_f32_dpp v17, v17, v17 row_ror:8 row_mask:0xf bank_mask:0xf
    v_mov_b32 v21, v17
    s_nop 1
    v_permlane16_swap_b32 v17, v21
    v_add_f32 v17, v17, v21
    v_mov_b32 v21, v17
    s_nop 1
    v_permlane32_swap_b32 v17, v21
    v_add_f32 v17, v17, v21
    v_add_f32_dpp v18, v18, v18 row_ror:8 row_mask:0xf bank_mask:0xf
    v_mov_b32 v22, v18
    s_nop 1
    v_permlane16_swap_b32 v18, v22
    v_add_f32 v18, v18, v22
    v_mov_b32 v22, v18
    s_nop 1
    v_permlane32_swap_b32 v18, v22
    v_add_f32 v18, v18, v22
    v_add_f32_dpp v19, v19, v19 row_ror:8 row_mask:0xf bank_mask:0xf
    v_mov_b32 v23, v19
    s_nop 1
    v_permlane16_swap_b32 v19, v23
    v_add_f32 v19, v19, v23
    v_mov_b32 v23, v19
    s_nop 1
    v_permlane32_swap_b32 v19, v23
    v_add_f32 v19, v19, v23
    v_cvt_pk_bf16_f32 v16, v16, v16
    v_and_b32 v16, 0xffff0000, v16
    v_add_f32 v16, v16, v50
    v_cvt_pk_bf16_f32 v16, v16, v16
    v_and_b32 v16, 0xffff0000, v16
    v_cvt_pk_bf16_f32 v17, v17, v17
    v_and_b32 v17, 0xffff0000, v17
    v_add_f32 v17, v17, v51
    v_cvt_pk_bf16_f32 v17, v17, v17
    v_and_b32 v17, 0xffff0000, v17
    v_cvt_pk_bf16_f32 v18, v18, v18
    v_and_b32 v18, 0xffff0000, v18
    v_add_f32 v18, v18, v52
    v_cvt_pk_bf16_f32 v18, v18, v18
    v_and_b32 v18, 0xffff0000, v18
    v_cvt_pk_bf16_f32 v19, v19, v19
    v_and_b32 v19, 0xffff0000, v19
    v_add_f32 v19, v19, v53
    v_cvt_pk_bf16_f32 v19, v19, v19
    v_and_b32 v19, 0xffff0000, v19
    s_add_u32 s76, s86, 186368
L_f3pre:
    buffer_load_dwordx4 v[64:67], v14, s[12:15], s76 offen sc1
    s_waitcnt vmcnt(0)
    v_max_u32 v9, v64, v65
    v_max3_u32 v9, v9, v66, v67
    v_cmp_eq_u32 vcc, -1, v9
    s_nop 1
    s_cbranch_vccnz L_f3pre2
    s_branch L_f3poll
L_f3pre2:
    s_add_u32 s89, s89, 1
    s_cmp_gt_u32 s89, 100000
    s_cbranch_scc1 L_f3poll
    s_sleep 2
    s_branch L_f3pre
L_f3poll:
    s_mov_b32 s75, s86
    buffer_load_dwordx4 v[64:67], v14, s[12:15], s75 offen sc1
    s_add_u32 s75, s75, 14336
    buffer_load_dwordx4 v[68:71], v14, s[12:15], s75 offen sc1
    s_add_u32 s75, s75, 14336
    buffer_load_dwordx4 v[72:75], v14, s[12:15], s75 offen sc1
    s_add_u32 s75, s75, 14336
    buffer_load_dwordx4 v[76:79], v14, s[12:15], s75 offen sc1
    s_add_u32 s75, s75, 14336
    buffer_load_dwordx4 v[80:83], v14, s[12:15], s75 offen sc1
    s_add_u32 s75, s75, 14336
    buffer_load_dwordx4 v[84:87], v14, s[12:15], s75 offen sc1
    s_add_u32 s75, s75, 14336
    buffer_load_dwordx4 v[88:91], v14, s[12:15], s75 offen sc1
    s_add_u32 s75, s75, 14336
    buffer_load_dwordx4 v[92:95], v14, s[12:15], s75 offen sc1
    s_add_u32 s75, s75, 14336
    buffer_load_dwordx4 v[96:99], v14, s[12:15], s75 offen sc1
    s_add_u32 s75, s75, 14336
    buffer_load_dwordx4 v[100:103], v14, s[12:15], s75 offen sc1
    s_add_u32 s75, s75, 14336
    buffer_load_dwordx4 v[104:107], v14, s[12:15], s75 offen sc1
    s_add_u32 s75, s75, 14336
    buffer_load_dwordx4 v[108:111], v14, s[12:15], s75 offen sc1
    s_add_u32 s75, s75, 14336
    buffer_load_dwordx4 v[112:115], v14, s[12:15], s75 offen sc1
    s_add_u32 s75, s75, 14336
    buffer_load_dwordx4 v[116:119], v14, s[12:15], s75 offen sc1
    s_waitcnt vmcnt(0)
    v_max_u32 v9, v64, v65
    v_max3_u32 v9, v9, v66, v67
    v_max3_u32 v9, v9, v68, v69
    v_max3_u32 v9, v9, v70, v71
    v_max3_u32 v9, v9, v72, v73
    v_max3_u32 v9, v9, v74, v75
    v_max3_u32 v9, v9, v76, v77
    v_max3_u32 v9, v9, v78, v79
    v_max3_u32 v9, v9, v80, v81
    v_max3_u32 v9, v9, v82, v83
    v_max3_u32 v9, v9, v84, v85
    v_max3_u32 v9, v9, v86, v87
    v_max3_u32 v9, v9, v88, v89
    v_max3_u32 v9, v9, v90, v91
    v_max3_u32 v9, v9, v92, v93
    v_max3_u32 v9, v9, v94, v95
    v_max3_u32 v9, v9, v96, v97
    v_max3_u32 v9, v9, v98, v99
    v_max3_u32 v9, v9, v100, v101
    v_max3_u32 v9, v9, v102, v103
    v_max3_u32 v9, v9, v104, v105
    v_max3_u32 v9, v9, v106, v107
    v_max3_u32 v9, v9, v108, v109
    v_max3_u32 v9, v9, v110, v111
    v_max3_u32 v9, v9, v112, v113
    v_max3_u32 v9, v9, v114, v115
    v_max3_u32 v9, v9, v116, v117
    v_max3_u32 v9, v9, v118, v119
    v_cmp_eq_u32 vcc, -1, v9
    s_nop 1
    s_cbranch_vccnz L_f3re
    s_branch L_f3go
L_f3re:
    s_add_u32 s89, s89, 1
    s_cmp_gt_u32 s89, 100000
    s_cbranch_scc1 L_f3go
    s_branch L_f3poll
L_f3go:
    v_add_f32 v64, v64, v92
    v_add_f32 v65, v65, v93
    v_add_f32 v66, v66, v94
    v_add_f32 v67, v67, v95
    v_add_f32 v68, v68, v96
    v_add_f32 v69, v69, v97
    v_add_f32 v70, v70, v98
    v_add_f32 v71, v71, v99
    v_add_f32 v72, v72, v100
    v_add_f32 v73, v73, v101
    v_add_f32 v74, v74, v102
    v_add_f32 v75, v75, v103
    v_add_f32 v76, v76, v104
    v_add_f32 v77, v77, v105
    v_add_f32 v78, v78, v106
    v_add_f32 v79, v79, v107
    v_add_f32 v80, v80, v108
    v_add_f32 v81, v81, v109
    v_add_f32 v82, v82, v110
    v_add_f32 v83, v83, v111
    v_add_f32 v84, v84, v112
    v_add_f32 v85, v85, v113
    v_add_f32 v86, v86, v114
    v_add_f32 v87, v87, v115
    v_add_f32 v88, v88, v116
    v_add_f32 v89, v89, v117
    v_add_f32 v90, v90, v118
    v_add_f32 v91, v91, v119
    v_add_f32 v64, v64, v80
    v_add_f32 v65, v65, v81
    v_add_f32 v66, v66, v82
    v_add_f32 v67, v67, v83
    v_add_f32 v68, v68, v84
    v_add_f32 v69, v69, v85
    v_add_f32 v70, v70, v86
    v_add_f32 v71, v71, v87
    v_add_f32 v72, v72, v88
    v_add_f32 v73, v73, v89
    v_add_f32 v74, v74, v90
    v_add_f32 v75, v75, v91
    v_add_f32 v64, v64, v68
    v_add_f32 v65, v65, v69
    v_add_f32 v66, v66, v70
    v_add_f32 v67, v67, v71
    v_add_f32 v72, v72, v76
    v_add_f32 v73, v73, v77
    v_add_f32 v74, v74, v78
    v_add_f32 v75, v75, v79
    v_add_f32 v64, v64, v72
    v_add_f32 v65, v65, v73
    v_add_f32 v66, v66, v74
    v_add_f32 v67, v67, v75
    v_add_f32_dpp v64, v64, v64 row_ror:8 row_mask:0xf bank_mask:0xf
    v_mov_b32 v20, v64
    s_nop 1
    v_permlane16_swap_b32 v64, v20
    v_add_f32 v64, v64, v20
    v_mov_b32 v20, v64
    s_nop 1
    v_permlane32_swap_b32 v64, v20
    v_add_f32 v64, v64, v20
    v_add_f32_dpp v65, v65, v65 row_ror:8 row_mask:0xf bank_mask:0xf
    v_mov_b32 v21, v65
    s_nop 1
    v_permlane16_swap_b32 v65, v21
    v_add_f32 v65, v65, v21
    v_mov_b32 v21, v65
    s_nop 1
    v_permlane32_swap_b32 v65, v21
    v_add_f32 v65, v65, v21
    v_add_f32_dpp v66, v66, v66 row_ror:8 row_mask:0xf bank_mask:0xf
    v_mov_b32 v22, v66
    s_nop 1
    v_permlane16_swap_b32 v66, v22
    v_add_f32 v66, v66, v22
    v_mov_b32 v22, v66
    s_nop 1
    v_permlane32_swap_b32 v66, v22
    v_add_f32 v66, v66, v22
    v_add_f32_dpp v67, v67, v67 row_ror:8 row_mask:0xf bank_mask:0xf
    v_mov_b32 v23, v67
    s_nop 1
    v_permlane16_swap_b32 v67, v23
    v_add_f32 v67, v67, v23
    v_mov_b32 v23, v67
    s_nop 1
    v_permlane32_swap_b32 v67, v23
    v_add_f32 v67, v67, v23
    v_cvt_pk_bf16_f32 v64, v64, v64
    v_and_b32 v64, 0xffff0000, v64
    v_add_f32 v64, v64, v16
    v_cvt_pk_bf16_f32 v65, v65, v65
    v_and_b32 v65, 0xffff0000, v65
    v_add_f32 v65, v65, v17
    v_cvt_pk_bf16_f32 v66, v66, v66
    v_and_b32 v66, 0xffff0000, v66
    v_add_f32 v66, v66, v18
    v_cvt_pk_bf16_f32 v67, v67, v67
    v_and_b32 v67, 0xffff0000, v67
    v_add_f32 v67, v67, v19
    v_cvt_pk_bf16_f32 v64, v64, v65
    v_cvt_pk_bf16_f32 v65, v66, v67
    v_cmp_gt_u32 vcc, 8, v1
    s_nop 1
    v_cndmask_b32 v12, v8, v12, vcc
    s_lshl_b32 s75, s82, 6
    buffer_store_dwordx2 v[64:65], v12, s[44:47], s75 offen
    s_branch L_end
L_helper:
    s_barrier
    buffer_load_dwordx4 v[60:63], v3, s[20:23], 0 offen
    v_lshrrev_b32 v9, 1, v1
    v_lshlrev_b32 v9, 13, v9
    v_and_b32 v10, 1, v1
    v_lshl_add_u32 v9, v10, 4, v9
    s_lshl_b32 s85, s72, 10
    s_lshl_b32 s76, s73, 5
    s_add_u32 s85, s85, s76
    s_mov_b32 s75, s85
    buffer_load_dwordx4 v[64:67], v9, s[24:27], s75 offen
    s_add_u32 s75, s75, 262144
    buffer_load_dwordx4 v[68:71], v9, s[24:27], s75 offen
    s_add_u32 s75, s75, 262144
    buffer_load_dwordx4 v[72:75], v9, s[24:27], s75 offen
    s_add_u32 s75, s75, 262144
    buffer_load_dwordx4 v[76:79], v9, s[24:27], s75 offen
    s_add_u32 s75, s75, 262144
    buffer_load_dwordx4 v[80:83], v9, s[24:27], s75 offen
    s_add_u32 s75, s75, 262144
    buffer_load_dwordx4 v[84:87], v9, s[24:27], s75 offen
    s_add_u32 s75, s75, 262144
    buffer_load_dwordx4 v[88:91], v9, s[24:27], s75 offen
    s_add_u32 s75, s75, 262144
    buffer_load_dwordx4 v[92:95], v9, s[24:27], s75 offen
    s_add_u32 s75, s75, 262144
    buffer_load_dwordx4 v[96:99], v9, s[24:27], s75 offen
    s_add_u32 s75, s75, 262144
    buffer_load_dwordx4 v[100:103], v9, s[24:27], s75 offen
    s_add_u32 s75, s75, 262144
    buffer_load_dwordx4 v[104:107], v9, s[24:27], s75 offen
    s_add_u32 s75, s75, 262144
    buffer_load_dwordx4 v[108:111], v9, s[24:27], s75 offen
    s_add_u32 s75, s75, 262144
    buffer_load_dwordx4 v[112:115], v9, s[24:27], s75 offen
    s_add_u32 s75, s75, 262144
    buffer_load_dwordx4 v[116:119], v9, s[24:27], s75 offen
    s_cmp_lg_u32 s87, 1
    s_cbranch_scc1 L_hnowo
    v_lshrrev_b32 v10, 3, v1
    v_mul_u32_u24 v10, 896, v10
    v_and_b32 v11, 7, v1
    v_lshl_add_u32 v10, v11, 4, v10
    s_lshl_b32 s75, s81, 8
    s_mul_i32 s75, s75, 896
    s_lshl_b32 s76, s82, 7
    s_add_u32 s75, s75, s76
    buffer_load_dwordx4 a[0:3], v10, s[28:31], s75 offen
    s_add_u32 s75, s75, 7168
    buffer_load_dwordx4 a[4:7], v10, s[28:31], s75 offen
    s_add_u32 s75, s75, 7168
    buffer_load_dwordx4 a[8:11], v10, s[28:31], s75 offen
    s_add_u32 s75, s75, 7168
    buffer_load_dwordx4 a[12:15], v10, s[28:31], s75 offen
    s_add_u32 s75, s75, 7168
    buffer_load_dwordx4 a[16:19], v10, s[28:31], s75 offen
    s_add_u32 s75, s75, 7168
    buffer_load_dwordx4 a[20:23], v10, s[28:31], s75 offen
    s_add_u32 s75, s75, 7168
    buffer_load_dwordx4 a[24:27], v10, s[28:31], s75 offen
    s_add_u32 s75, s75, 7168
    buffer_load_dwordx4 a[28:31], v10, s[28:31], s75 offen
    s_add_u32 s75, s75, 7168
    buffer_load_dwordx4 a[32:35], v10, s[28:31], s75 offen
    s_add_u32 s75, s75, 7168
    buffer_load_dwordx4 a[36:39], v10, s[28:31], s75 offen
    s_add_u32 s75, s75, 7168
    buffer_load_dwordx4 a[40:43], v10, s[28:31], s75 offen
    s_add_u32 s75, s75, 7168
    buffer_load_dwordx4 a[44:47], v10, s[28:31], s75 offen
    s_add_u32 s75, s75, 7168
    buffer_load_dwordx4 a[48:51], v10, s[28:31], s75 offen
    s_add_u32 s75, s75, 7168
    buffer_load_dwordx4 a[52:55], v10, s[28:31], s75 offen
    s_add_u32 s75, s75, 7168
    buffer_load_dwordx4 a[56:59], v10, s[28:31], s75 offen
    s_add_u32 s75, s75, 7168
    buffer_load_dwordx4 a[60:63], v10, s[28:31], s75 offen
    s_add_u32 s75, s75, 7168
    buffer_load_dwordx4 a[64:67], v10, s[28:31], s75 offen
    s_add_u32 s75, s75, 7168
    buffer_load_dwordx4 a[68:71], v10, s[28:31], s75 offen
    s_add_u32 s75, s75, 7168
    buffer_load_dwordx4 a[72:75], v10, s[28:31], s75 offen
    s_add_u32 s75, s75, 7168
    buffer_load_dwordx4 a[76:79], v10, s[28:31], s75 offen
    s_add_u32 s75, s75, 7168
    buffer_load_dwordx4 a[80:83], v10, s[28:31], s75 offen
    s_add_u32 s75, s75, 7168
    buffer_load_dwordx4 a[84:87], v10, s[28:31], s75 offen
    s_add_u32 s75, s75, 7168
    buffer_load_dwordx4 a[88:91], v10, s[28:31], s75 offen
    s_add_u32 s75, s75, 7168
    buffer_load_dwordx4 a[92:95], v10, s[28:31], s75 offen
    s_add_u32 s75, s75, 7168
    buffer_load_dwordx4 a[96:99], v10, s[28:31], s75 offen
    s_add_u32 s75, s75, 7168
    buffer_load_dwordx4 a[100:103], v10, s[28:31], s75 offen
    s_add_u32 s75, s75, 7168
    buffer_load_dwordx4 a[104:107], v10, s[28:31], s75 offen
    s_add_u32 s75, s75, 7168
    buffer_load_dwordx4 a[108:111], v10, s[28:31], s75 offen
    s_add_u32 s75, s75, 7168
    buffer_load_dwordx4 a[112:115], v10, s[28:31], s75 offen
    s_add_u32 s75, s75, 7168
    buffer_load_dwordx4 a[116:119], v10, s[28:31], s75 offen
    s_add_u32 s75, s75, 7168
    buffer_load_dwordx4 a[120:123], v10, s[28:31], s75 offen
    s_add_u32 s75, s75, 7168
    buffer_load_dwordx4 a[124:127], v10, s[28:31], s75 offen
L_hnowo:
    v_mov_b32 v12, -1
    v_mov_b32 v13, -1
    v_mov_b32 v14, -1
    v_mov_b32 v15, -1
    s_lshl_b32 s75, s72, 6
    s_add_u32 s75, s75, s73
    s_lshl_b32 s76, s75, 10
    s_add_u32 s76, s76, 16384
    s_add_u32 s77, s76, 32768
    buffer_store_dwordx4 v[12:15], v3, s[12:15], s76 offen sc1
    buffer_store_dwordx4 v[12:15], v3, s[12:15], s77 offen sc1
    s_lshl_b32 s76, s75, 3
    s_add_u32 s76, s76, 8192
    v_lshlrev_b32 v10, 8, v1
    v_cmp_gt_u32 vcc, 2, v1
    s_nop 1
    v_cndmask_b32 v10, v8, v10, vcc
    buffer_store_dwordx2 v[12:13], v10, s[12:15], s76 offen sc1
    s_cmp_lg_u32 s87, 1
    s_cbranch_scc1 L_noclr2
    s_mul_i32 s76, s81, 1792
    s_lshl_b32 s77, s82, 8
    s_add_u32 s76, s76, s77
    s_add_u32 s76, s76, 540672
    v_cmp_gt_u32 vcc, 16, v1
    s_nop 1
    v_cndmask_b32 v10, v8, v3, vcc
    buffer_store_dwordx4 v[12:15], v10, s[12:15], s76 offen sc1
L_noclr2:
    s_cmp_lg_u32 s87, 2
    s_cbranch_scc1 L_noclear
    s_mul_i32 s76, s83, 1792
    s_add_u32 s76, s76, 573440
    v_cmp_gt_u32 vcc, 48, v1
    s_nop 1
    v_cndmask_b32 v10, v8, v3, vcc
    buffer_store_dwordx4 v[12:15], v3, s[12:15], s76 offen sc1
    buffer_store_dwordx4 v[12:15], v10, s[12:15], s76 offen offset:1024 sc1
L_noclear:
    s_cmp_lg_u32 s87, 1
    s_cbranch_scc1 L_rwxa
    s_waitcnt vmcnt(50)
    s_branch L_rwxz
L_rwxa:
    s_cmp_lg_u32 s87, 2
    s_cbranch_scc1 L_rwxb
    s_waitcnt vmcnt(19)
    s_branch L_rwxz
L_rwxb:
    s_waitcnt vmcnt(17)
L_rwxz:
    v_lshlrev_b32 v16, 16, v60
    v_and_b32 v17, 0xffff0000, v60
    v_lshlrev_b32 v18, 16, v61
    v_and_b32 v19, 0xffff0000, v61
    v_lshlrev_b32 v20, 16, v62
    v_and_b32 v21, 0xffff0000, v62
    v_lshlrev_b32 v22, 16, v63
    v_and_b32 v23, 0xffff0000, v63
    v_add_f32 v9, v16, v17
    v_add_f32 v9, v9, v18
    v_add_f32 v9, v9, v19
    v_add_f32 v9, v9, v20
    v_add_f32 v9, v9, v21
    v_add_f32 v9, v9, v22
    v_add_f32 v9, v9, v23
    s_nop 1
    v_add_f32_dpp v9, v9, v9 quad_perm:[1,0,3,2] row_mask:0xf bank_mask:0xf
    s_nop 1
    v_add_f32_dpp v9, v9, v9 quad_perm:[2,3,0,1] row_mask:0xf bank_mask:0xf
    s_nop 1
    v_add_f32_dpp v9, v9, v9 row_half_mirror row_mask:0xf bank_mask:0xf
    s_nop 1
    v_add_f32_dpp v9, v9, v9 row_mirror row_mask:0xf bank_mask:0xf
    v_mov_b32 v10, v9
    s_nop 1
    v_permlane16_swap_b32 v9, v10
    v_add_f32 v9, v9, v10
    v_mov_b32 v10, v9
    s_nop 1
    v_permlane32_swap_b32 v9, v10
    v_add_f32 v9, v9, v10
    v_mul_f32 v9, 0x3b124925, v9
    v_mov_b32 v11, 0
    v_sub_f32 v10, v16, v9
    v_fmac_f32 v11, v10, v10
    v_sub_f32 v10, v17, v9
    v_fmac_f32 v11, v10, v10
    v_sub_f32 v10, v18, v9
    v_fmac_f32 v11, v10, v10
    v_sub_f32 v10, v19, v9
    v_fmac_f32 v11, v10, v10
    v_sub_f32 v10, v20, v9
    v_fmac_f32 v11, v10, v10
    v_sub_f32 v10, v21, v9
    v_fmac_f32 v11, v10, v10
    v_sub_f32 v10, v22, v9
    v_fmac_f32 v11, v10, v10
    v_sub_f32 v10, v23, v9
    v_fmac_f32 v11, v10, v10
    v_cmp_gt_u32 vcc, 56, v1
    s_nop 1
    v_cndmask_b32 v11, 0, v11, vcc
    s_nop 1
    v_add_f32_dpp v11, v11, v11 quad_perm:[1,0,3,2] row_mask:0xf bank_mask:0xf
    s_nop 1
    v_add_f32_dpp v11, v11, v11 quad_perm:[2,3,0,1] row_mask:0xf bank_mask:0xf
    s_nop 1
    v_add_f32_dpp v11, v11, v11 row_half_mirror row_mask:0xf bank_mask:0xf
    s_nop 1
    v_add_f32_dpp v11, v11, v11 row_mirror row_mask:0xf bank_mask:0xf
    v_mov_b32 v10, v11
    s_nop 1
    v_permlane16_swap_b32 v11, v10
    v_add_f32 v11, v11, v10
    v_mov_b32 v10, v11
    s_nop 1
    v_permlane32_swap_b32 v11, v10
    v_add_f32 v11, v11, v10
    v_mul_f32 v11, 0x3b124925, v11
    v_cvt_pk_bf16_f32 v9, v9, v9
    v_and_b32 v9, 0xffff0000, v9
    v_cvt_pk_bf16_f32 v11, v11, v11
    v_and_b32 v11, 0xffff0000, v11
    v_add_f32 v11, 0x3727c5ac, v11
    v_cvt_pk_bf16_f32 v11, v11, v11
    v_and_b32 v11, 0xffff0000, v11
    v_sqrt_f32 v11, v11
    s_nop 0
    v_cvt_pk_bf16_f32 v11, v11, v11
    v_and_b32 v11, 0xffff0000, v11
    v_rcp_f32 v10, v11
    v_sub_f32 v16, v16, v9
    v_cvt_pk_bf16_f32 v16, v16, v16
    v_and_b32 v16, 0xffff0000, v16
    v_mul_f32 v24, v16, v10
    v_fma_f32 v12, -v24, v11, v16
    v_fma_f32 v24, v12, v10, v24
    v_cvt_pk_bf16_f32 v24, v24, v24
    v_and_b32 v24, 0xffff0000, v24
    v_sub_f32 v17, v17, v9
    v_cvt_pk_bf16_f32 v17, v17, v17
    v_and_b32 v17, 0xffff0000, v17
    v_mul_f32 v25, v17, v10
    v_fma_f32 v12, -v25, v11, v17
    v_fma_f32 v25, v12, v10, v25
    v_cvt_pk_bf16_f32 v25, v25, v25
    v_and_b32 v25, 0xffff0000, v25
    v_sub_f32 v18, v18, v9
    v_cvt_pk_bf16_f32 v18, v18, v18
    v_and_b32 v18, 0xffff0000, v18
    v_mul_f32 v26, v18, v10
    v_fma_f32 v12, -v26, v11, v18
    v_fma_f32 v26, v12, v10, v26
    v_cvt_pk_bf16_f32 v26, v26, v26
    v_and_b32 v26, 0xffff0000, v26
    v_sub_f32 v19, v19, v9
    v_cvt_pk_bf16_f32 v19, v19, v19
    v_and_b32 v19, 0xffff0000, v19
    v_mul_f32 v27, v19, v10
    v_fma_f32 v12, -v27, v11, v19
    v_fma_f32 v27, v12, v10, v27
    v_cvt_pk_bf16_f32 v27, v27, v27
    v_and_b32 v27, 0xffff0000, v27
    v_sub_f32 v20, v20, v9
    v_cvt_pk_bf16_f32 v20, v20, v20
    v_and_b32 v20, 0xffff0000, v20
    v_mul_f32 v28, v20, v10
    v_fma_f32 v12, -v28, v11, v20
    v_fma_f32 v28, v12, v10, v28
    v_cvt_pk_bf16_f32 v28, v28, v28
    v_and_b32 v28, 0xffff0000, v28
    v_sub_f32 v21, v21, v9
    v_cvt_pk_bf16_f32 v21, v21, v21
    v_and_b32 v21, 0xffff0000, v21
    v_mul_f32 v29, v21, v10
    v_fma_f32 v12, -v29, v11, v21
    v_fma_f32 v29, v12, v10, v29
    v_cvt_pk_bf16_f32 v29, v29, v29
    v_and_b32 v29, 0xffff0000, v29
    v_sub_f32 v22, v22, v9
    v_cvt_pk_bf16_f32 v22, v22, v22
    v_and_b32 v22, 0xffff0000, v22
    v_mul_f32 v30, v22, v10
    v_fma_f32 v12, -v30, v11, v22
    v_fma_f32 v30, v12, v10, v30
    v_cvt_pk_bf16_f32 v30, v30, v30
    v_and_b32 v30, 0xffff0000, v30
    v_sub_f32 v23, v23, v9
    v_cvt_pk_bf16_f32 v23, v23, v23
    v_and_b32 v23, 0xffff0000, v23
    v_mul_f32 v31, v23, v10
    v_fma_f32 v12, -v31, v11, v23
    v_fma_f32 v31, v12, v10, v31
    v_cvt_pk_bf16_f32 v31, v31, v31
    v_and_b32 v31, 0xffff0000, v31
    v_lshlrev_b32 v12, 5, v1
    v_cmp_gt_u32 vcc, 56, v1
    s_nop 0
    s_and_saveexec_b64 s[98:99], vcc
    ds_write_b128 v12, v[24:27] offset:0
    ds_write_b128 v12, v[28:31] offset:16
    s_mov_b64 exec, s[98:99]
    v_lshrrev_b32 v12, 1, v1
    v_lshlrev_b32 v12, 2, v12
    s_waitcnt lgkmcnt(0)
    ds_read_b32 v32, v12 offset:0
    ds_read_b32 v34, v12 offset:128
    ds_read_b32 v36, v12 offset:256
    ds_read_b32 v38, v12 offset:384
    ds_read_b32 v40, v12 offset:512
    ds_read_b32 v42, v12 offset:640
    ds_read_b32 v44, v12 offset:768
    ds_read_b32 v46, v12 offset:896
    ds_read_b32 v48, v12 offset:1024
    ds_read_b32 v50, v12 offset:1152
    ds_read_b32 v52, v12 offset:1280
    ds_read_b32 v54, v12 offset:1408
    ds_read_b32 v56, v12 offset:1536
    ds_read_b32 v58, v12 offset:1664
    v_mov_b32 v16, 0
    v_mov_b32 v17, 0
    v_mov_b32 v18, 0
    v_mov_b32 v19, 0
    v_mov_b32 v20, 0
    v_mov_b32 v21, 0
    v_mov_b32 v22, 0
    v_mov_b32 v23, 0
    s_waitcnt lgkmcnt(0)
    s_cmp_lg_u32 s87, 1
    s_cbranch_scc1 L_rwwa
    s_waitcnt vmcnt(36)
    s_branch L_rwwz
L_rwwa:
    s_cmp_lg_u32 s87, 2
    s_cbranch_scc1 L_rwwb
    s_waitcnt vmcnt(5)
    s_branch L_rwwz
L_rwwb:
    s_waitcnt vmcnt(3)
L_rwwz:
    v_lshlrev_b32 v24, 16, v64
    v_and_b32 v25, 0xffff0000, v64
    v_lshlrev_b32 v26, 16, v65
    v_and_b32 v27, 0xffff0000, v65
    v_lshlrev_b32 v28, 16, v66
    v_and_b32 v29, 0xffff0000, v66
    v_lshlrev_b32 v30, 16, v67
    v_and_b32 v31, 0xffff0000, v67
    v_pk_fma_f32 v[16:17], v[24:25], v[32:33], v[16:17] op_sel_hi:[1,0,1]
    v_pk_fma_f32 v[18:19], v[26:27], v[32:33], v[18:19] op_sel_hi:[1,0,1]
    v_pk_fma_f32 v[20:21], v[28:29], v[32:33], v[20:21] op_sel_hi:[1,0,1]
    v_pk_fma_f32 v[22:23], v[30:31], v[32:33], v[22:23] op_sel_hi:[1,0,1]
    v_lshlrev_b32 v24, 16, v68
    v_and_b32 v25, 0xffff0000, v68
    v_lshlrev_b32 v26, 16, v69
    v_and_b32 v27, 0xffff0000, v69
    v_lshlrev_b32 v28, 16, v70
    v_and_b32 v29, 0xffff0000, v70
    v_lshlrev_b32 v30, 16, v71
    v_and_b32 v31, 0xffff0000, v71
    v_pk_fma_f32 v[16:17], v[24:25], v[34:35], v[16:17] op_sel_hi:[1,0,1]
    v_pk_fma_f32 v[18:19], v[26:27], v[34:35], v[18:19] op_sel_hi:[1,0,1]
    v_pk_fma_f32 v[20:21], v[28:29], v[34:35], v[20:21] op_sel_hi:[1,0,1]
    v_pk_fma_f32 v[22:23], v[30:31], v[34:35], v[22:23] op_sel_hi:[1,0,1]
    v_lshlrev_b32 v24, 16, v72
    v_and_b32 v25, 0xffff0000, v72
    v_lshlrev_b32 v26, 16, v73
    v_and_b32 v27, 0xffff0000, v73
    v_lshlrev_b32 v28, 16, v74
    v_and_b32 v29, 0xffff0000, v74
    v_lshlrev_b32 v30, 16, v75
    v_and_b32 v31, 0xffff0000, v75
    v_pk_fma_f32 v[16:17], v[24:25], v[36:37], v[16:17] op_sel_hi:[1,0,1]
    v_pk_fma_f32 v[18:19], v[26:27], v[36:37], v[18:19] op_sel_hi:[1,0,1]
    v_pk_fma_f32 v[20:21], v[28:29], v[36:37], v[20:21] op_sel_hi:[1,0,1]
    v_pk_fma_f32 v[22:23], v[30:31], v[36:37], v[22:23] op_sel_hi:[1,0,1]
    v_lshlrev_b32 v24, 16, v76
    v_and_b32 v25, 0xffff0000, v76
    v_lshlrev_b32 v26, 16, v77
    v_and_b32 v27, 0xffff0000, v77
    v_lshlrev_b32 v28, 16, v78
    v_and_b32 v29, 0xffff0000, v78
    v_lshlrev_b32 v30, 16, v79
    v_and_b32 v31, 0xffff0000, v79
    v_pk_fma_f32 v[16:17], v[24:25], v[38:39], v[16:17] op_sel_hi:[1,0,1]
    v_pk_fma_f32 v[18:19], v[26:27], v[38:39], v[18:19] op_sel_hi:[1,0,1]
    v_pk_fma_f32 v[20:21], v[28:29], v[38:39], v[20:21] op_sel_hi:[1,0,1]
    v_pk_fma_f32 v[22:23], v[30:31], v[38:39], v[22:23] op_sel_hi:[1,0,1]
    v_lshlrev_b32 v24, 16, v80
    v_and_b32 v25, 0xffff0000, v80
    v_lshlrev_b32 v26, 16, v81
    v_and_b32 v27, 0xffff0000, v81
    v_lshlrev_b32 v28, 16, v82
    v_and_b32 v29, 0xffff0000, v82
    v_lshlrev_b32 v30, 16, v83
    v_and_b32 v31, 0xffff0000, v83
    v_pk_fma_f32 v[16:17], v[24:25], v[40:41], v[16:17] op_sel_hi:[1,0,1]
    v_pk_fma_f32 v[18:19], v[26:27], v[40:41], v[18:19] op_sel_hi:[1,0,1]
    v_pk_fma_f32 v[20:21], v[28:29], v[40:41], v[20:21] op_sel_hi:[1,0,1]
    v_pk_fma_f32 v[22:23], v[30:31], v[40:41], v[22:23] op_sel_hi:[1,0,1]
    v_lshlrev_b32 v24, 16, v84
    v_and_b32 v25, 0xffff0000, v84
    v_lshlrev_b32 v26, 16, v85
    v_and_b32 v27, 0xffff0000, v85
    v_lshlrev_b32 v28, 16, v86
    v_and_b32 v29, 0xffff0000, v86
    v_lshlrev_b32 v30, 16, v87
    v_and_b32 v31, 0xffff0000, v87
    v_pk_fma_f32 v[16:17], v[24:25], v[42:43], v[16:17] op_sel_hi:[1,0,1]
    v_pk_fma_f32 v[18:19], v[26:27], v[42:43], v[18:19] op_sel_hi:[1,0,1]
    v_pk_fma_f32 v[20:21], v[28:29], v[42:43], v[20:21] op_sel_hi:[1,0,1]
    v_pk_fma_f32 v[22:23], v[30:31], v[42:43], v[22:23] op_sel_hi:[1,0,1]
    v_lshlrev_b32 v24, 16, v88
    v_and_b32 v25, 0xffff0000, v88
    v_lshlrev_b32 v26, 16, v89
    v_and_b32 v27, 0xffff0000, v89
    v_lshlrev_b32 v28, 16, v90
    v_and_b32 v29, 0xffff0000, v90
    v_lshlrev_b32 v30, 16, v91
    v_and_b32 v31, 0xffff0000, v91
    v_pk_fma_f32 v[16:17], v[24:25], v[44:45], v[16:17] op_sel_hi:[1,0,1]
    v_pk_fma_f32 v[18:19], v[26:27], v[44:45], v[18:19] op_sel_hi:[1,0,1]
    v_pk_fma_f32 v[20:21], v[28:29], v[44:45], v[20:21] op_sel_hi:[1,0,1]
    v_pk_fma_f32 v[22:23], v[30:31], v[44:45], v[22:23] op_sel_hi:[1,0,1]
    v_lshlrev_b32 v24, 16, v92
    v_and_b32 v25, 0xffff0000, v92
    v_lshlrev_b32 v26, 16, v93
    v_and_b32 v27, 0xffff0000, v93
    v_lshlrev_b32 v28, 16, v94
    v_and_b32 v29, 0xffff0000, v94
    v_lshlrev_b32 v30, 16, v95
    v_and_b32 v31, 0xffff0000, v95
    v_pk_fma_f32 v[16:17], v[24:25], v[46:47], v[16:17] op_sel_hi:[1,0,1]
    v_pk_fma_f32 v[18:19], v[26:27], v[46:47], v[18:19] op_sel_hi:[1,0,1]
    v_pk_fma_f32 v[20:21], v[28:29], v[46:47], v[20:21] op_sel_hi:[1,0,1]
    v_pk_fma_f32 v[22:23], v[30:31], v[46:47], v[22:23] op_sel_hi:[1,0,1]
    v_lshlrev_b32 v24, 16, v96
    v_and_b32 v25, 0xffff0000, v96
    v_lshlrev_b32 v26, 16, v97
    v_and_b32 v27, 0xffff0000, v97
    v_lshlrev_b32 v28, 16, v98
    v_and_b32 v29, 0xffff0000, v98
    v_lshlrev_b32 v30, 16, v99
    v_and_b32 v31, 0xffff0000, v99
    v_pk_fma_f32 v[16:17], v[24:25], v[48:49], v[16:17] op_sel_hi:[1,0,1]
    v_pk_fma_f32 v[18:19], v[26:27], v[48:49], v[18:19] op_sel_hi:[1,0,1]
    v_pk_fma_f32 v[20:21], v[28:29], v[48:49], v[20:21] op_sel_hi:[1,0,1]
    v_pk_fma_f32 v[22:23], v[30:31], v[48:49], v[22:23] op_sel_hi:[1,0,1]
    v_lshlrev_b32 v24, 16, v100
    v_and_b32 v25, 0xffff0000, v100
    v_lshlrev_b32 v26, 16, v101
    v_and_b32 v27, 0xffff0000, v101
    v_lshlrev_b32 v28, 16, v102
    v_and_b32 v29, 0xffff0000, v102
    v_lshlrev_b32 v30, 16, v103
    v_and_b32 v31, 0xffff0000, v103
    v_pk_fma_f32 v[16:17], v[24:25], v[50:51], v[16:17] op_sel_hi:[1,0,1]
    v_pk_fma_f32 v[18:19], v[26:27], v[50:51], v[18:19] op_sel_hi:[1,0,1]
    v_pk_fma_f32 v[20:21], v[28:29], v[50:51], v[20:21] op_sel_hi:[1,0,1]
    v_pk_fma_f32 v[22:23], v[30:31], v[50:51], v[22:23] op_sel_hi:[1,0,1]
    v_lshlrev_b32 v24, 16, v104
    v_and_b32 v25, 0xffff0000, v104
    v_lshlrev_b32 v26, 16, v105
    v_and_b32 v27, 0xffff0000, v105
    v_lshlrev_b32 v28, 16, v106
    v_and_b32 v29, 0xffff0000, v106
    v_lshlrev_b32 v30, 16, v107
    v_and_b32 v31, 0xffff0000, v107
    v_pk_fma_f32 v[16:17], v[24:25], v[52:53], v[16:17] op_sel_hi:[1,0,1]
    v_pk_fma_f32 v[18:19], v[26:27], v[52:53], v[18:19] op_sel_hi:[1,0,1]
    v_pk_fma_f32 v[20:21], v[28:29], v[52:53], v[20:21] op_sel_hi:[1,0,1]
    v_pk_fma_f32 v[22:23], v[30:31], v[52:53], v[22:23] op_sel_hi:[1,0,1]
    v_lshlrev_b32 v24, 16, v108
    v_and_b32 v25, 0xffff0000, v108
    v_lshlrev_b32 v26, 16, v109
    v_and_b32 v27, 0xffff0000, v109
    v_lshlrev_b32 v28, 16, v110
    v_and_b32 v29, 0xffff0000, v110
    v_lshlrev_b32 v30, 16, v111
    v_and_b32 v31, 0xffff0000, v111
    v_pk_fma_f32 v[16:17], v[24:25], v[54:55], v[16:17] op_sel_hi:[1,0,1]
    v_pk_fma_f32 v[18:19], v[26:27], v[54:55], v[18:19] op_sel_hi:[1,0,1]
    v_pk_fma_f32 v[20:21], v[28:29], v[54:55], v[20:21] op_sel_hi:[1,0,1]
    v_pk_fma_f32 v[22:23], v[30:31], v[54:55], v[22:23] op_sel_hi:[1,0,1]
    v_lshlrev_b32 v24, 16, v112
    v_and_b32 v25, 0xffff0000, v112
    v_lshlrev_b32 v26, 16, v113
    v_and_b32 v27, 0xffff0000, v113
    v_lshlrev_b32 v28, 16, v114
    v_and_b32 v29, 0xffff0000, v114
    v_lshlrev_b32 v30, 16, v115
    v_and_b32 v31, 0xffff0000, v115
    v_pk_fma_f32 v[16:17], v[24:25], v[56:57], v[16:17] op_sel_hi:[1,0,1]
    v_pk_fma_f32 v[18:19], v[26:27], v[56:57], v[18:19] op_sel_hi:[1,0,1]
    v_pk_fma_f32 v[20:21], v[28:29], v[56:57], v[20:21] op_sel_hi:[1,0,1]
    v_pk_fma_f32 v[22:23], v[30:31], v[56:57], v[22:23] op_sel_hi:[1,0,1]
    v_lshlrev_b32 v24, 16, v116
    v_and_b32 v25, 0xffff0000, v116
    v_lshlrev_b32 v26, 16, v117
    v_and_b32 v27, 0xffff0000, v117
    v_lshlrev_b32 v28, 16, v118
    v_and_b32 v29, 0xffff0000, v118
    v_lshlrev_b32 v30, 16, v119
    v_and_b32 v31, 0xffff0000, v119
    v_pk_fma_f32 v[16:17], v[24:25], v[58:59], v[16:17] op_sel_hi:[1,0,1]
    v_pk_fma_f32 v[18:19], v[26:27], v[58:59], v[18:19] op_sel_hi:[1,0,1]
    v_pk_fma_f32 v[20:21], v[28:29], v[58:59], v[20:21] op_sel_hi:[1,0,1]
    v_pk_fma_f32 v[22:23], v[30:31], v[58:59], v[22:23] op_sel_hi:[1,0,1]
    v_add_f32_dpp v16, v16, v16 quad_perm:[2,3,0,1] row_mask:0xf bank_mask:0xf
    v_add_f32_dpp v17, v17, v17 quad_perm:[2,3,0,1] row_mask:0xf bank_mask:0xf
    v_add_f32_dpp v18, v18, v18 quad_perm:[2,3,0,1] row_mask:0xf bank_mask:0xf
    v_add_f32_dpp v19, v19, v19 quad_perm:[2,3,0,1] row_mask:0xf bank_mask:0xf
    v_add_f32_dpp v20, v20, v20 quad_perm:[2,3,0,1] row_mask:0xf bank_mask:0xf
    v_add_f32_dpp v21, v21, v21 quad_perm:[2,3,0,1] row_mask:0xf bank_mask:0xf
    v_add_f32_dpp v22, v22, v22 quad_perm:[2,3,0,1] row_mask:0xf bank_mask:0xf
    v_add_f32_dpp v23, v23, v23 quad_perm:[2,3,0,1] row_mask:0xf bank_mask:0xf
    v_add_f32_dpp v16, v16, v16 row_ror:4 row_mask:0xf bank_mask:0xf
    v_add_f32_dpp v17, v17, v17 row_ror:4 row_mask:0xf bank_mask:0xf
    v_add_f32_dpp v18, v18, v18 row_ror:4 row_mask:0xf bank_mask:0xf
    v_add_f32_dpp v19, v19, v19 row_ror:4 row_mask:0xf bank_mask:0xf
    v_add_f32_dpp v20, v20, v20 row_ror:4 row_mask:0xf bank_mask:0xf
    v_add_f32_dpp v21, v21, v21 row_ror:4 row_mask:0xf bank_mask:0xf
    v_add_f32_dpp v22, v22, v22 row_ror:4 row_mask:0xf bank_mask:0xf
    v_add_f32_dpp v23, v23, v23 row_ror:4 row_mask:0xf bank_mask:0xf
    v_add_f32_dpp v16, v16, v16 row_ror:8 row_mask:0xf bank_mask:0xf
    v_add_f32_dpp v17, v17, v17 row_ror:8 row_mask:0xf bank_mask:0xf
    v_add_f32_dpp v18, v18, v18 row_ror:8 row_mask:0xf bank_mask:0xf
    v_add_f32_dpp v19, v19, v19 row_ror:8 row_mask:0xf bank_mask:0xf
    v_add_f32_dpp v20, v20, v20 row_ror:8 row_mask:0xf bank_mask:0xf
    v_add_f32_dpp v21, v21, v21 row_ror:8 row_mask:0xf bank_mask:0xf
    v_add_f32_dpp v22, v22, v22 row_ror:8 row_mask:0xf bank_mask:0xf
    v_add_f32_dpp v23, v23, v23 row_ror:8 row_mask:0xf bank_mask:0xf
    v_mov_b32 v24, v16
    s_nop 1
    v_permlane16_swap_b32 v16, v24
    v_add_f32 v16, v16, v24
    v_mov_b32 v24, v16
    s_nop 1
    v_permlane32_swap_b32 v16, v24
    v_add_f32 v16, v16, v24
    v_mov_b32 v25, v17
    s_nop 1
    v_permlane16_swap_b32 v17, v25
    v_add_f32 v17, v17, v25
    v_mov_b32 v25, v17
    s_nop 1
    v_permlane32_swap_b32 v17, v25
    v_add_f32 v17, v17, v25
    v_mov_b32 v26, v18
    s_nop 1
    v_permlane16_swap_b32 v18, v26
    v_add_f32 v18, v18, v26
    v_mov_b32 v26, v18
    s_nop 1
    v_permlane32_swap_b32 v18, v26
    v_add_f32 v18, v18, v26
    v_mov_b32 v27, v19
    s_nop 1
    v_permlane16_swap_b32 v19, v27
    v_add_f32 v19, v19, v27
    v_mov_b32 v27, v19
    s_nop 1
    v_permlane32_swap_b32 v19, v27
    v_add_f32 v19, v19, v27
    v_mov_b32 v28, v20
    s_nop 1
    v_permlane16_swap_b32 v20, v28
    v_add_f32 v20, v20, v28
    v_mov_b32 v28, v20
    s_nop 1
    v_permlane32_swap_b32 v20, v28
    v_add_f32 v20, v20, v28
    v_mov_b32 v29, v21
    s_nop 1
    v_permlane16_swap_b32 v21, v29
    v_add_f32 v21, v21, v29
    v_mov_b32 v29, v21
    s_nop 1
    v_permlane32_swap_b32 v21, v29
    v_add_f32 v21, v21, v29
    v_mov_b32 v30, v22
    s_nop 1
    v_permlane16_swap_b32 v22, v30
    v_add_f32 v22, v22, v30
    v_mov_b32 v30, v22
    s_nop 1
    v_permlane32_swap_b32 v22, v30
    v_add_f32 v22, v22, v30
    v_mov_b32 v31, v23
    s_nop 1
    v_permlane16_swap_b32 v23, v31
    v_add_f32 v23, v23, v31
    v_mov_b32 v31, v23
    s_nop 1
    v_permlane32_swap_b32 v23, v31
    v_add_f32 v23, v23, v31
    v_cvt_pk_bf16_f32 v16, v16, v17
    v_cvt_pk_bf16_f32 v17, v18, v19
    v_cvt_pk_bf16_f32 v18, v20, v21
    v_cvt_pk_bf16_f32 v19, v22, v23
    v_cmp_gt_u32 vcc, 2, v1
    s_nop 1
    v_cndmask_b32 v12, v8, v3, vcc
    s_add_u32 s75, s85, 0
    buffer_store_dwordx4 v[16:19], v12, s[12:15], s75 offen sc1
    s_waitcnt vmcnt(0)
    v_mov_b32 v12, 1
    v_cmp_eq_u32 vcc, 0, v1
    s_nop 1
    v_cndmask_b32 v13, v8, v1, vcc
    s_lshl_b32 s75, s72, 5
    s_add_u32 s76, s75, s73
    buffer_store_byte v12, v13, s[16:19], s76 offen sc1
    s_barrier
    s_barrier
    v_and_b32 v13, 7, v1
    v_lshlrev_b32 v13, 2, v13
L_fpoll:
    buffer_load_dword v12, v13, s[16:19], s75 offen sc1
    s_waitcnt vmcnt(0)
    v_cmp_ne_u32 vcc, 0x01010101, v12
    s_nop 1
    s_cbranch_vccz L_fok
    s_add_u32 s89, s89, 1
    s_cmp_gt_u32 s89, 100000
    s_cbranch_scc1 L_fok
    s_sleep 2
    s_branch L_fpoll
L_fok:
    s_lshl_b32 s75, s72, 10
    s_add_u32 s75, s75, 0
    buffer_load_dwordx4 v[16:19], v3, s[12:15], s75 offen sc1
    s_waitcnt vmcnt(0)
    ds_write_b128 v3, v[16:19] offset:2048
    v_mov_b32 v12, 0
    v_mov_b32 v13, 0
    ds_write_b64 v12, v[12:13] offset:19552
    s_waitcnt lgkmcnt(0)
    s_barrier
    s_cmp_eq_u32 s87, 0
    s_cbranch_scc1 L_end
    v_mov_b32 v13, 0
    s_cmp_eq_u32 s87, 2
    s_cselect_b32 s77, 6, 4
L_hcnt:
    ds_read_b32 v14, v13 offset:19552
    s_waitcnt lgkmcnt(0)
    v_cmp_gt_u32 vcc, s77, v14
    s_nop 1
    s_cbranch_vccz L_hcntok
    s_add_u32 s89, s89, 1
    s_cmp_gt_u32 s89, 100000
    s_cbranch_scc1 L_hcntok
    s_sleep 1
    s_branch L_hcnt
L_hcntok:
    s_cmp_lg_u32 s87, 1
    s_cbranch_scc1 L_hnowo2
    s_waitcnt vmcnt(0)
    v_add_u32 v9, 32768, v3
    ds_write_b128 v9, a[0:3] offset:0
    ds_write_b128 v9, a[4:7] offset:1024
    ds_write_b128 v9, a[8:11] offset:2048
    ds_write_b128 v9, a[12:15] offset:3072
    ds_write_b128 v9, a[16:19] offset:4096
    ds_write_b128 v9, a[20:23] offset:5120
    ds_write_b128 v9, a[24:27] offset:6144
    ds_write_b128 v9, a[28:31] offset:7168
    ds_write_b128 v9, a[32:35] offset:8192
    ds_write_b128 v9, a[36:39] offset:9216
    ds_write_b128 v9, a[40:43] offset:10240
    ds_write_b128 v9, a[44:47] offset:11264
    ds_write_b128 v9, a[48:51] offset:12288
    ds_write_b128 v9, a[52:55] offset:13312
    ds_write_b128 v9, a[56:59] offset:14336
    ds_write_b128 v9, a[60:63] offset:15360
    ds_write_b128 v9, a[64:67] offset:16384
    ds_write_b128 v9, a[68:71] offset:17408
    ds_write_b128 v9, a[72:75] offset:18432
    ds_write_b128 v9, a[76:79] offset:19456
    ds_write_b128 v9, a[80:83] offset:20480
    ds_write_b128 v9, a[84:87] offset:21504
    ds_write_b128 v9, a[88:91] offset:22528
    ds_write_b128 v9, a[92:95] offset:23552
    ds_write_b128 v9, a[96:99] offset:24576
    ds_write_b128 v9, a[100:103] offset:25600
    ds_write_b128 v9, a[104:107] offset:26624
    ds_write_b128 v9, a[108:111] offset:27648
    ds_write_b128 v9, a[112:115] offset:28672
    ds_write_b128 v9, a[116:119] offset:29696
    ds_write_b128 v9, a[120:123] offset:30720
    ds_write_b128 v9, a[124:127] offset:31744
L_hnowo2:
    s_cmp_lg_u32 s87, 2
    s_cbranch_scc1 L_hnoffn
    v_lshrrev_b32 v10, 1, v1
    v_mul_u32_u24 v10, 3584, v10
    v_and_b32 v11, 1, v1
    v_lshl_add_u32 v10, v11, 4, v10
    s_lshl_b32 s75, s83, 5
    s_mov_b32 m0, 32768
    s_nop 0
    buffer_load_dwordx4 v10, s[32:35], s75 offen lds
    s_mov_b32 m0, 47104
    s_nop 0
    buffer_load_dwordx4 v10, s[36:39], s75 offen lds
    s_add_u32 s75, s75, 114688
    s_mov_b32 m0, 33792
    s_nop 0
    buffer_load_dwordx4 v10, s[32:35], s75 offen lds
    s_mov_b32 m0, 48128
    s_nop 0
    buffer_load_dwordx4 v10, s[36:39], s75 offen lds
    s_add_u32 s75, s75, 114688
    s_mov_b32 m0, 34816
    s_nop 0
    buffer_load_dwordx4 v10, s[32:35], s75 offen lds
    s_mov_b32 m0, 49152
    s_nop 0
    buffer_load_dwordx4 v10, s[36:39], s75 offen lds
    s_add_u32 s75, s75, 114688
    s_mov_b32 m0, 35840
    s_nop 0
    buffer_load_dwordx4 v10, s[32:35], s75 offen lds
    s_mov_b32 m0, 50176
    s_nop 0
    buffer_load_dwordx4 v10, s[36:39], s75 offen lds
    s_add_u32 s75, s75, 114688
    s_mov_b32 m0, 36864
    s_nop 0
    buffer_load_dwordx4 v10, s[32:35], s75 offen lds
    s_mov_b32 m0, 51200
    s_nop 0
    buffer_load_dwordx4 v10, s[36:39], s75 offen lds
    s_add_u32 s75, s75, 114688
    s_mov_b32 m0, 37888
    s_nop 0
    buffer_load_dwordx4 v10, s[32:35], s75 offen lds
    s_mov_b32 m0, 52224
    s_nop 0
    buffer_load_dwordx4 v10, s[36:39], s75 offen lds
    s_add_u32 s75, s75, 114688
    s_mov_b32 m0, 38912
    s_nop 0
    buffer_load_dwordx4 v10, s[32:35], s75 offen lds
    s_mov_b32 m0, 53248
    s_nop 0
    buffer_load_dwordx4 v10, s[36:39], s75 offen lds
    s_add_u32 s75, s75, 114688
    s_mov_b32 m0, 39936
    s_nop 0
    buffer_load_dwordx4 v10, s[32:35], s75 offen lds
    s_mov_b32 m0, 54272
    s_nop 0
    buffer_load_dwordx4 v10, s[36:39], s75 offen lds
    s_add_u32 s75, s75, 114688
    s_mov_b32 m0, 40960
    s_nop 0
    buffer_load_dwordx4 v10, s[32:35], s75 offen lds
    s_mov_b32 m0, 55296
    s_nop 0
    buffer_load_dwordx4 v10, s[36:39], s75 offen lds
    s_add_u32 s75, s75, 114688
    s_mov_b32 m0, 41984
    s_nop 0
    buffer_load_dwordx4 v10, s[32:35], s75 offen lds
    s_mov_b32 m0, 56320
    s_nop 0
    buffer_load_dwordx4 v10, s[36:39], s75 offen lds
    s_add_u32 s75, s75, 114688
    s_mov_b32 m0, 43008
    s_nop 0
    buffer_load_dwordx4 v10, s[32:35], s75 offen lds
    s_mov_b32 m0, 57344
    s_nop 0
    buffer_load_dwordx4 v10, s[36:39], s75 offen lds
    s_add_u32 s75, s75, 114688
    s_mov_b32 m0, 44032
    s_nop 0
    buffer_load_dwordx4 v10, s[32:35], s75 offen lds
    s_mov_b32 m0, 58368
    s_nop 0
    buffer_load_dwordx4 v10, s[36:39], s75 offen lds
    s_add_u32 s75, s75, 114688
    s_mov_b32 m0, 45056
    s_nop 0
    buffer_load_dwordx4 v10, s[32:35], s75 offen lds
    s_mov_b32 m0, 59392
    s_nop 0
    buffer_load_dwordx4 v10, s[36:39], s75 offen lds
    s_add_u32 s75, s75, 114688
    s_mov_b32 m0, 46080
    s_nop 0
    buffer_load_dwordx4 v10, s[32:35], s75 offen lds
    s_mov_b32 m0, 60416
    s_nop 0
    buffer_load_dwordx4 v10, s[36:39], s75 offen lds
    s_mul_i32 s86, s83, 14336
    s_mov_b32 m0, 61440
    s_nop 0
    buffer_load_dwordx4 v3, s[40:43], s86 offen lds
    s_add_u32 s86, s86, 1024
    s_mov_b32 m0, 62464
    s_nop 0
    buffer_load_dwordx4 v3, s[40:43], s86 offen lds
    s_add_u32 s86, s86, 1024
    s_mov_b32 m0, 63488
    s_nop 0
    buffer_load_dwordx4 v3, s[40:43], s86 offen lds
    s_add_u32 s86, s86, 1024
    s_mov_b32 m0, 64512
    s_nop 0
    buffer_load_dwordx4 v3, s[40:43], s86 offen lds
    s_add_u32 s86, s86, 1024
    s_mov_b32 m0, 65536
    s_nop 0
    buffer_load_dwordx4 v3, s[40:43], s86 offen lds
    s_add_u32 s86, s86, 1024
    s_mov_b32 m0, 66560
    s_nop 0
    buffer_load_dwordx4 v3, s[40:43], s86 offen lds
    s_add_u32 s86, s86, 1024
    s_mov_b32 m0, 67584
    s_nop 0
    buffer_load_dwordx4 v3, s[40:43], s86 offen lds
    s_add_u32 s86, s86, 1024
    s_mov_b32 m0, 68608
    s_nop 0
    buffer_load_dwordx4 v3, s[40:43], s86 offen lds
    s_add_u32 s86, s86, 1024
    s_mov_b32 m0, 69632
    s_nop 0
    buffer_load_dwordx4 v3, s[40:43], s86 offen lds
    s_add_u32 s86, s86, 1024
    s_mov_b32 m0, 70656
    s_nop 0
    buffer_load_dwordx4 v3, s[40:43], s86 offen lds
    s_add_u32 s86, s86, 1024
    s_mov_b32 m0, 71680
    s_nop 0
    buffer_load_dwordx4 v3, s[40:43], s86 offen lds
    s_add_u32 s86, s86, 1024
    s_mov_b32 m0, 72704
    s_nop 0
    buffer_load_dwordx4 v3, s[40:43], s86 offen lds
    s_add_u32 s86, s86, 1024
    s_mov_b32 m0, 73728
    s_nop 0
    buffer_load_dwordx4 v3, s[40:43], s86 offen lds
    s_add_u32 s86, s86, 1024
    s_mov_b32 m0, 74752
    s_nop 0
    buffer_load_dwordx4 v3, s[40:43], s86 offen lds
L_hnoffn:
    v_lshlrev_b32 v13, 2, v1
L_afpoll:
    buffer_load_dword v12, v13, s[16:19], 0 offen sc1
    s_waitcnt vmcnt(0)
    v_cmp_ne_u32 vcc, 0x01010101, v12
    s_nop 1
    s_cbranch_vccz L_afok
    s_add_u32 s89, s89, 1
    s_cmp_gt_u32 s89, 100000
    s_cbranch_scc1 L_afok
    s_sleep 8
    s_branch L_afpoll
L_afok:
    v_mov_b32 v12, 0
    v_mov_b32 v13, 1
    s_waitcnt lgkmcnt(0)
    ds_write_b32 v12, v13 offset:19556
    s_waitcnt lgkmcnt(0)
L_end:
    s_endpgm
.section .rodata,"a"
.p2align 6
.amdhsa_kernel sequential_preLN__gqa_block_cached__geglu_ffn__decode_kernel
  .amdhsa_next_free_vgpr 256
  .amdhsa_next_free_sgpr 102
  .amdhsa_accum_offset 128
  .amdhsa_group_segment_fixed_size 0
  .amdhsa_kernarg_size 96
  .amdhsa_user_sgpr_count 2
  .amdhsa_user_sgpr_kernarg_segment_ptr 1
  .amdhsa_system_sgpr_workgroup_id_x 1
.end_amdhsa_kernel
```
